```python
import torch

def _softmax(x, axis=-1):
    return torch.softmax(x, dim=axis)
def _gelu(x):
    return torch.nn.functional.gelu(x, approximate="tanh")
def _silu(x):
    return torch.nn.functional.silu(x)
def _sigmoid(x):
    return torch.sigmoid(x)
def _layernorm(x, axis=-1, eps=1e-5):
    m = x.mean(dim=axis, keepdim=True)
    v = x.var(dim=axis, keepdim=True, unbiased=False)
    return (x - m) / torch.sqrt(v + eps)
def _scatter_add(tgt, idx, src, axis=0):
    return tgt.clone().index_add_(axis, idx, src)
def _segment_sum(src, seg, n):
    out = torch.zeros((n,) + src.shape[1:], dtype=src.dtype)
    return out.index_add_(0, seg, src)
def _pad(x, pw):
    flat = tuple(v for pair in reversed(pw) for v in pair)
    return torch.nn.functional.pad(x, flat)

kernel_name = 'recurrent_scan__softmax_full_mha__glu_gated_geglu__prompt'

def setup_inputs():

    _w = (lambda a: (lambda t: t.to(torch.bfloat16) if t.is_floating_point() else t)(torch.as_tensor(a)))
    def _A_setup():
        B, S, D = 1, 2048, 512
        return {
            "x": _w((lambda *s: torch.randn(*s, dtype=torch.bfloat16) * 0.05)(B, S, D)),
            "wqkv": _w((lambda *s: torch.randn(*s, dtype=torch.bfloat16) * 0.2)(D, 3 * D)),
            "wo": _w((lambda *s: torch.randn(*s, dtype=torch.bfloat16) * 0.2)(D, D)),
        }
    _A_in = _A_setup()

    def _B_setup():
        B, S, Dm, Df = 1, 2048, 512, 1792
        return {
            "x": _w((lambda *s: torch.randn(*s, dtype=torch.bfloat16) * 0.05)(B, S, Dm)),
            "w_gate": _w((lambda *s: torch.randn(*s, dtype=torch.bfloat16) * 0.1)(Dm, Df) * (Dm ** -0.5)),
            "w_up": _w((lambda *s: torch.randn(*s, dtype=torch.bfloat16) * 0.1)(Dm, Df) * (Dm ** -0.5)),
            "w_down": _w((lambda *s: torch.randn(*s, dtype=torch.bfloat16) * 0.1)(Df, Dm) * (Df ** -0.5)),
        }
    _B_in = _B_setup()

    return {
        "A_x": _A_in["x"],
        "A_wqkv": _A_in["wqkv"],
        "A_wo": _A_in["wo"],
        "B_x": _B_in["x"],
        "B_w_gate": _B_in["w_gate"],
        "B_w_up": _B_in["w_up"],
        "B_w_down": _B_in["w_down"],
    }

def reference(A_x, A_wqkv, A_wo, B_x, B_w_gate, B_w_up, B_w_down):
    def _A_ref(x, wqkv, wo):
        B, S, D = x.shape
        H = 32; Dh = D // H
        qkv = (lambda x, *d: x.permute(*d))((x @ wqkv).reshape(B, S, 3, H, Dh), 2, 0, 3, 1, 4)
        q, k, v = qkv[0], qkv[1], qkv[2]
        scale = Dh ** -0.5
        scores = torch.einsum("bhqd,bhkd->bhqk", q, k) * scale
        p = _softmax(scores, axis=-1)
        o = torch.einsum("bhqk,bhkd->bhqd", p, v)
        return (lambda x, *d: x.permute(*d))(o, 0, 2, 1, 3).reshape(B, S, D) @ wo

    def _B_ref(x, w_gate, w_up, w_down):
        g = torch.einsum("bsd,df->bsf", x, w_gate)
        u = torch.einsum("bsd,df->bsf", x, w_up)
        h = _gelu(g) * u
        return torch.einsum("bsf,fd->bsd", h, w_down)

    x = A_x
    xn = _layernorm(x, axis=-1)
    s = _A_ref(xn, A_wqkv, A_wo)
    g = _silu(_B_ref(xn, B_w_gate, B_w_up, B_w_down))
    return x + s * g
```

```asm
; @launch kernel=k1_kernel grid=(256,1,1) block=(512,1,1) lds=156928
; @launch kernel=k2_kernel grid=(256,1,1) block=(768,1,1) lds=131072
; @launch kernel=k3_kernel grid=(256,1,1) block=(256,1,1) lds=65536
.amdgcn_target "amdgcn-amd-amdhsa--gfx950"
.text
.p2align 8
.globl k1_kernel
.type k1_kernel,@function
k1_kernel:
    s_cmp_ge_u32 s2, 256
    s_cbranch_scc1 k1_kernel_end
    s_load_dwordx4 s[40:43], s[0:1], 0
    s_load_dwordx4 s[44:47], s[0:1], 32
    s_load_dwordx2 s[48:49], s[0:1], 16
    s_load_dwordx2 s[50:51], s[0:1], 48
    s_load_dwordx2 s[52:53], s[0:1], 72
    v_lshrrev_b32 v2, 6, v0
    v_and_b32 v1, 63, v0
    s_nop 0
    v_readfirstlane_b32 s3, v2
    s_bfe_u32 s4, s2, 0x20001
    s_lshl_b32 s4, s4, 2
    s_lshr_b32 s5, s2, 6
    s_add_u32 s4, s4, s5
    s_and_b32 s5, s2, 1
    s_lshl_b32 s5, s5, 3
    s_bfe_u32 s6, s2, 0x30003
    s_add_u32 s5, s5, s6
    s_and_b32 s6, s3, 3
    s_lshr_b32 s7, s3, 2
    s_mov_b32 s67, 0x3f803f80
    s_mov_b32 s68, 0xffff0000
    s_lshl_b32 s59, s4, 2
    s_add_u32 s59, s59, s6
    v_lshlrev_b32 v2, 4, v1
    v_and_b32 v14, 31, v1
    v_lshrrev_b32 v15, 5, v1
    s_mul_i32 s54, s6, 33280
    v_mul_u32_u24 v3, 1040, v14
    v_lshl_add_u32 v3, v15, 5, v3
    v_add_u32 v3, s54, v3
    v_bfe_u32 v16, v1, 4, 1
    v_lshlrev_b32 v4, 16, v16
    v_lshl_add_u32 v4, v15, 8, v4
    v_and_b32 v16, 15, v1
    v_lshl_add_u32 v4, v16, 4, v4
    v_bfe_u32 v16, v1, 2, 2
    v_lshl_add_u32 v16, v15, 4, v16
    v_and_b32 v17, 3, v1
    v_bfe_u32 v14, v1, 4, 1
    v_mul_u32_u24 v8, 224, v16
    v_lshl_add_u32 v8, v17, 3, v8
    v_mul_u32_u24 v9, 7296, v14
    v_add_u32 v8, v8, v9
    v_lshlrev_b32 v9, 6, v16
    v_lshl_add_u32 v9, v17, 3, v9
    v_lshl_add_u32 v9, v14, 5, v9
    v_add_u32 v9, 14592, v9
    s_waitcnt lgkmcnt(0)
    s_mov_b32 s8, s40
    s_and_b32 s9, s41, 0xffff
    s_mov_b32 s10, 2097152
    s_mov_b32 s11, 0x00020000
    s_lshl_b32 s54, s4, 17
    s_lshl_b32 s55, s3, 14
    s_add_u32 s54, s54, s55
    s_mul_i32 s55, s3, 16640
    s_add_u32 m0, s55, 0
    s_add_u32 s56, s54, 0
    buffer_load_dwordx4 v2, s[8:11], s56 offen lds
    s_add_u32 m0, s55, 1040
    s_add_u32 s56, s54, 1024
    buffer_load_dwordx4 v2, s[8:11], s56 offen lds
    s_add_u32 m0, s55, 2080
    s_add_u32 s56, s54, 2048
    buffer_load_dwordx4 v2, s[8:11], s56 offen lds
    s_add_u32 m0, s55, 3120
    s_add_u32 s56, s54, 3072
    buffer_load_dwordx4 v2, s[8:11], s56 offen lds
    s_add_u32 m0, s55, 4160
    s_add_u32 s56, s54, 4096
    buffer_load_dwordx4 v2, s[8:11], s56 offen lds
    s_add_u32 m0, s55, 5200
    s_add_u32 s56, s54, 5120
    buffer_load_dwordx4 v2, s[8:11], s56 offen lds
    s_add_u32 m0, s55, 6240
    s_add_u32 s56, s54, 6144
    buffer_load_dwordx4 v2, s[8:11], s56 offen lds
    s_add_u32 m0, s55, 7280
    s_add_u32 s56, s54, 7168
    buffer_load_dwordx4 v2, s[8:11], s56 offen lds
    s_add_u32 m0, s55, 8320
    s_add_u32 s56, s54, 8192
    buffer_load_dwordx4 v2, s[8:11], s56 offen lds
    s_add_u32 m0, s55, 9360
    s_add_u32 s56, s54, 9216
    buffer_load_dwordx4 v2, s[8:11], s56 offen lds
    s_add_u32 m0, s55, 10400
    s_add_u32 s56, s54, 10240
    buffer_load_dwordx4 v2, s[8:11], s56 offen lds
    s_add_u32 m0, s55, 11440
    s_add_u32 s56, s54, 11264
    buffer_load_dwordx4 v2, s[8:11], s56 offen lds
    s_add_u32 m0, s55, 12480
    s_add_u32 s56, s54, 12288
    buffer_load_dwordx4 v2, s[8:11], s56 offen lds
    s_add_u32 m0, s55, 13520
    s_add_u32 s56, s54, 13312
    buffer_load_dwordx4 v2, s[8:11], s56 offen lds
    s_add_u32 m0, s55, 14560
    s_add_u32 s56, s54, 14336
    buffer_load_dwordx4 v2, s[8:11], s56 offen lds
    s_add_u32 m0, s55, 15600
    s_add_u32 s56, s54, 15360
    buffer_load_dwordx4 v2, s[8:11], s56 offen lds
    s_mov_b32 s12, s52
    s_and_b32 s13, s53, 0xffff
    s_mov_b32 s14, 33554432
    s_mov_b32 s15, 0x00020000
    s_add_u32 s54, s3, 0
    s_cmp_lt_u32 s54, 7
    s_cselect_b32 s24, s44, s46
    s_cselect_b32 s25, s45, s47
    s_cselect_b32 s55, 0, 7
    s_cselect_b32 s56, 0, 7296
    s_sub_u32 s55, s54, s55
    s_lshl_b32 s57, s55, 10
    s_add_u32 s36, s56, s57
    s_lshl_b32 s55, s55, 6
    s_sub_u32 s56, s54, 14
    s_cmp_ge_u32 s54, 14
    s_cselect_b32 s24, s42, s24
    s_cselect_b32 s25, s43, s25
    s_and_b32 s25, s25, 0xffff
    s_mov_b32 s27, 0x00020000
    s_lshl_b32 s57, s56, 10
    s_add_u32 s57, s57, 14592
    s_cmp_ge_u32 s54, 14
    s_cselect_b32 s36, s57, s36
    s_mov_b32 s64, 114688
    s_cselect_b32 s57, 1, 0
    s_cmp_eq_u32 s57, 1
    s_cbranch_scc0 k1_kernel_p0_mlp
    s_mov_b32 s64, 98304
    s_mov_b32 s26, 1572864
    s_and_b32 s55, s56, 1
    s_lshl_b32 s55, s55, 4
    v_lshrrev_b32 v14, 2, v1
    v_add_u32 v14, s55, v14
    v_mul_u32_u24 v5, 3072, v14
    v_and_b32 v14, 3, v1
    v_lshl_add_u32 v5, v14, 4, v5
    s_lshr_b32 s55, s56, 1
    s_lshl_b32 s55, s55, 10
    s_lshl_b32 s57, s5, 6
    s_add_u32 s55, s55, s57
    v_add_u32 v5, s55, v5
    s_cmp_ge_u32 s54, 20
    s_cselect_b32 s26, 0, s26
    s_branch k1_kernel_p0_done
k1_kernel_p0_mlp:
    s_mov_b32 s26, 1835008
    v_add_u32 v14, s55, v1
    v_mul_u32_u24 v15, 4682, v14
    v_lshrrev_b32 v15, 16, v15
    v_mul_u32_u24 v5, 14, v15
    v_sub_u32 v14, v14, v5
    v_mul_u32_u24 v5, 3584, v15
    v_lshl_add_u32 v5, v14, 4, v5
    s_mul_i32 s57, s5, 224
    v_add_u32 v5, s57, v5
k1_kernel_p0_done:
    s_mov_b32 s60, 0
    s_add_u32 s54, s3, 8
    s_cmp_lt_u32 s54, 7
    s_cselect_b32 s28, s44, s46
    s_cselect_b32 s29, s45, s47
    s_cselect_b32 s55, 0, 7
    s_cselect_b32 s56, 0, 7296
    s_sub_u32 s55, s54, s55
    s_lshl_b32 s57, s55, 10
    s_add_u32 s37, s56, s57
    s_lshl_b32 s55, s55, 6
    s_sub_u32 s56, s54, 14
    s_cmp_ge_u32 s54, 14
    s_cselect_b32 s28, s42, s28
    s_cselect_b32 s29, s43, s29
    s_and_b32 s29, s29, 0xffff
    s_mov_b32 s31, 0x00020000
    s_lshl_b32 s57, s56, 10
    s_add_u32 s57, s57, 14592
    s_cmp_ge_u32 s54, 14
    s_cselect_b32 s37, s57, s37
    s_mov_b32 s65, 114688
    s_cselect_b32 s57, 1, 0
    s_cmp_eq_u32 s57, 1
    s_cbranch_scc0 k1_kernel_p1_mlp
    s_mov_b32 s65, 98304
    s_mov_b32 s30, 1572864
    s_and_b32 s55, s56, 1
    s_lshl_b32 s55, s55, 4
    v_lshrrev_b32 v14, 2, v1
    v_add_u32 v14, s55, v14
    v_mul_u32_u24 v6, 3072, v14
    v_and_b32 v14, 3, v1
    v_lshl_add_u32 v6, v14, 4, v6
    s_lshr_b32 s55, s56, 1
    s_lshl_b32 s55, s55, 10
    s_lshl_b32 s57, s5, 6
    s_add_u32 s55, s55, s57
    v_add_u32 v6, s55, v6
    s_cmp_ge_u32 s54, 20
    s_cselect_b32 s30, 0, s30
    s_branch k1_kernel_p1_done
k1_kernel_p1_mlp:
    s_mov_b32 s30, 1835008
    v_add_u32 v14, s55, v1
    v_mul_u32_u24 v15, 4682, v14
    v_lshrrev_b32 v15, 16, v15
    v_mul_u32_u24 v6, 14, v15
    v_sub_u32 v14, v14, v6
    v_mul_u32_u24 v6, 3584, v15
    v_lshl_add_u32 v6, v14, 4, v6
    s_mul_i32 s57, s5, 224
    v_add_u32 v6, s57, v6
k1_kernel_p1_done:
    s_mov_b32 s61, 0
    s_add_u32 s54, s3, 16
    s_cmp_lt_u32 s54, 7
    s_cselect_b32 s32, s44, s46
    s_cselect_b32 s33, s45, s47
    s_cselect_b32 s55, 0, 7
    s_cselect_b32 s56, 0, 7296
    s_sub_u32 s55, s54, s55
    s_lshl_b32 s57, s55, 10
    s_add_u32 s38, s56, s57
    s_lshl_b32 s55, s55, 6
    s_sub_u32 s56, s54, 14
    s_cmp_ge_u32 s54, 14
    s_cselect_b32 s32, s42, s32
    s_cselect_b32 s33, s43, s33
    s_and_b32 s33, s33, 0xffff
    s_mov_b32 s35, 0x00020000
    s_lshl_b32 s57, s56, 10
    s_add_u32 s57, s57, 14592
    s_cmp_ge_u32 s54, 14
    s_cselect_b32 s38, s57, s38
    s_mov_b32 s66, 114688
    s_cselect_b32 s57, 1, 0
    s_cmp_eq_u32 s57, 1
    s_cbranch_scc0 k1_kernel_p2_mlp
    s_mov_b32 s66, 98304
    s_mov_b32 s34, 1572864
    s_and_b32 s55, s56, 1
    s_lshl_b32 s55, s55, 4
    v_lshrrev_b32 v14, 2, v1
    v_add_u32 v14, s55, v14
    v_mul_u32_u24 v7, 3072, v14
    v_and_b32 v14, 3, v1
    v_lshl_add_u32 v7, v14, 4, v7
    s_lshr_b32 s55, s56, 1
    s_lshl_b32 s55, s55, 10
    s_lshl_b32 s57, s5, 6
    s_add_u32 s55, s55, s57
    v_add_u32 v7, s55, v7
    s_cmp_ge_u32 s54, 20
    s_cselect_b32 s34, 0, s34
    s_branch k1_kernel_p2_done
k1_kernel_p2_mlp:
    s_mov_b32 s34, 1835008
    v_add_u32 v14, s55, v1
    v_mul_u32_u24 v15, 4682, v14
    v_lshrrev_b32 v15, 16, v15
    v_mul_u32_u24 v7, 14, v15
    v_sub_u32 v14, v14, v7
    v_mul_u32_u24 v7, 3584, v15
    v_lshl_add_u32 v7, v14, 4, v7
    s_mul_i32 s57, s5, 224
    v_add_u32 v7, s57, v7
k1_kernel_p2_done:
    s_mov_b32 s62, 0
    s_cmp_ge_u32 s3, 4
    s_cselect_b32 s75, 1, 0
    s_add_u32 m0, s36, 133120
    s_nop 0
    buffer_load_dwordx4 v5, s[24:27], s60 offen lds
    s_add_u32 s60, s60, s64
    s_add_u32 m0, s37, 133120
    s_nop 0
    buffer_load_dwordx4 v6, s[28:31], s61 offen lds
    s_add_u32 s61, s61, s65
    s_add_u32 s57, s38, 133120
    s_cmp_eq_u32 s75, 1
    s_cselect_b32 m0, 153856, s57
    s_nop 0
    buffer_load_dwordx4 v7, s[32:35], s62 offen lds
    s_add_u32 s62, s62, s66
    v_mov_b32 v22, s67
    v_mov_b32 v23, s67
    v_mov_b32 v24, s67
    v_mov_b32 v25, s67
    s_waitcnt vmcnt(3)
    s_barrier
    ds_read_b128 v[42:45], v3 offset:0
    ds_read_b128 v[46:49], v3 offset:16
    ds_read_b128 v[50:53], v3 offset:64
    ds_read_b128 v[54:57], v3 offset:80
    ds_read_b128 v[58:61], v3 offset:128
    ds_read_b128 v[62:65], v3 offset:144
    ds_read_b128 v[66:69], v3 offset:192
    ds_read_b128 v[70:73], v3 offset:208
    ds_read_b128 v[74:77], v3 offset:256
    ds_read_b128 v[78:81], v3 offset:272
    ds_read_b128 v[82:85], v3 offset:320
    ds_read_b128 v[86:89], v3 offset:336
    ds_read_b128 v[90:93], v3 offset:384
    ds_read_b128 v[94:97], v3 offset:400
    ds_read_b128 v[98:101], v3 offset:448
    ds_read_b128 v[102:105], v3 offset:464
    ds_read_b128 v[106:109], v3 offset:512
    ds_read_b128 v[110:113], v3 offset:528
    ds_read_b128 v[114:117], v3 offset:576
    ds_read_b128 v[118:121], v3 offset:592
    ds_read_b128 v[122:125], v3 offset:640
    ds_read_b128 v[126:129], v3 offset:656
    ds_read_b128 v[130:133], v3 offset:704
    ds_read_b128 v[134:137], v3 offset:720
    ds_read_b128 v[138:141], v3 offset:768
    ds_read_b128 v[142:145], v3 offset:784
    ds_read_b128 v[146:149], v3 offset:832
    ds_read_b128 v[150:153], v3 offset:848
    ds_read_b128 v[154:157], v3 offset:896
    ds_read_b128 v[158:161], v3 offset:912
    ds_read_b128 v[162:165], v3 offset:960
    ds_read_b128 v[166:169], v3 offset:976
    s_cmp_eq_u32 s7, 1
    s_cbranch_scc1 k1_kernel_stat1
    s_waitcnt lgkmcnt(15)
    s_waitcnt lgkmcnt(0)
    v_mfma_f32_32x32x16_bf16 a[0:15], v[22:25], v[42:45], 0
    v_dot2_f32_bf16 v14, v42, v42, 0
    v_dot2_f32_bf16 v15, v43, v43, 0
    v_dot2_f32_bf16 v16, v44, v44, 0
    v_dot2_f32_bf16 v17, v45, v45, 0
    v_mfma_f32_32x32x16_bf16 a[0:15], v[22:25], v[46:49], a[0:15]
    v_dot2_f32_bf16 v14, v46, v46, v14
    v_dot2_f32_bf16 v15, v47, v47, v15
    v_dot2_f32_bf16 v16, v48, v48, v16
    v_dot2_f32_bf16 v17, v49, v49, v17
    v_mfma_f32_32x32x16_bf16 a[0:15], v[22:25], v[50:53], a[0:15]
    v_dot2_f32_bf16 v14, v50, v50, v14
    v_dot2_f32_bf16 v15, v51, v51, v15
    v_dot2_f32_bf16 v16, v52, v52, v16
    v_dot2_f32_bf16 v17, v53, v53, v17
    v_mfma_f32_32x32x16_bf16 a[0:15], v[22:25], v[54:57], a[0:15]
    v_dot2_f32_bf16 v14, v54, v54, v14
    v_dot2_f32_bf16 v15, v55, v55, v15
    v_dot2_f32_bf16 v16, v56, v56, v16
    v_dot2_f32_bf16 v17, v57, v57, v17
    v_mfma_f32_32x32x16_bf16 a[0:15], v[22:25], v[58:61], a[0:15]
    v_dot2_f32_bf16 v14, v58, v58, v14
    v_dot2_f32_bf16 v15, v59, v59, v15
    v_dot2_f32_bf16 v16, v60, v60, v16
    v_dot2_f32_bf16 v17, v61, v61, v17
    v_mfma_f32_32x32x16_bf16 a[0:15], v[22:25], v[62:65], a[0:15]
    v_dot2_f32_bf16 v14, v62, v62, v14
    v_dot2_f32_bf16 v15, v63, v63, v15
    v_dot2_f32_bf16 v16, v64, v64, v16
    v_dot2_f32_bf16 v17, v65, v65, v17
    v_mfma_f32_32x32x16_bf16 a[0:15], v[22:25], v[66:69], a[0:15]
    v_dot2_f32_bf16 v14, v66, v66, v14
    v_dot2_f32_bf16 v15, v67, v67, v15
    v_dot2_f32_bf16 v16, v68, v68, v16
    v_dot2_f32_bf16 v17, v69, v69, v17
    v_mfma_f32_32x32x16_bf16 a[0:15], v[22:25], v[70:73], a[0:15]
    v_dot2_f32_bf16 v14, v70, v70, v14
    v_dot2_f32_bf16 v15, v71, v71, v15
    v_dot2_f32_bf16 v16, v72, v72, v16
    v_dot2_f32_bf16 v17, v73, v73, v17
    v_mfma_f32_32x32x16_bf16 a[0:15], v[22:25], v[74:77], a[0:15]
    v_dot2_f32_bf16 v14, v74, v74, v14
    v_dot2_f32_bf16 v15, v75, v75, v15
    v_dot2_f32_bf16 v16, v76, v76, v16
    v_dot2_f32_bf16 v17, v77, v77, v17
    v_mfma_f32_32x32x16_bf16 a[0:15], v[22:25], v[78:81], a[0:15]
    v_dot2_f32_bf16 v14, v78, v78, v14
    v_dot2_f32_bf16 v15, v79, v79, v15
    v_dot2_f32_bf16 v16, v80, v80, v16
    v_dot2_f32_bf16 v17, v81, v81, v17
    v_mfma_f32_32x32x16_bf16 a[0:15], v[22:25], v[82:85], a[0:15]
    v_dot2_f32_bf16 v14, v82, v82, v14
    v_dot2_f32_bf16 v15, v83, v83, v15
    v_dot2_f32_bf16 v16, v84, v84, v16
    v_dot2_f32_bf16 v17, v85, v85, v17
    v_mfma_f32_32x32x16_bf16 a[0:15], v[22:25], v[86:89], a[0:15]
    v_dot2_f32_bf16 v14, v86, v86, v14
    v_dot2_f32_bf16 v15, v87, v87, v15
    v_dot2_f32_bf16 v16, v88, v88, v16
    v_dot2_f32_bf16 v17, v89, v89, v17
    v_mfma_f32_32x32x16_bf16 a[0:15], v[22:25], v[90:93], a[0:15]
    v_dot2_f32_bf16 v14, v90, v90, v14
    v_dot2_f32_bf16 v15, v91, v91, v15
    v_dot2_f32_bf16 v16, v92, v92, v16
    v_dot2_f32_bf16 v17, v93, v93, v17
    v_mfma_f32_32x32x16_bf16 a[0:15], v[22:25], v[94:97], a[0:15]
    v_dot2_f32_bf16 v14, v94, v94, v14
    v_dot2_f32_bf16 v15, v95, v95, v15
    v_dot2_f32_bf16 v16, v96, v96, v16
    v_dot2_f32_bf16 v17, v97, v97, v17
    v_mfma_f32_32x32x16_bf16 a[0:15], v[22:25], v[98:101], a[0:15]
    v_dot2_f32_bf16 v14, v98, v98, v14
    v_dot2_f32_bf16 v15, v99, v99, v15
    v_dot2_f32_bf16 v16, v100, v100, v16
    v_dot2_f32_bf16 v17, v101, v101, v17
    v_mfma_f32_32x32x16_bf16 a[0:15], v[22:25], v[102:105], a[0:15]
    v_dot2_f32_bf16 v14, v102, v102, v14
    v_dot2_f32_bf16 v15, v103, v103, v15
    v_dot2_f32_bf16 v16, v104, v104, v16
    v_dot2_f32_bf16 v17, v105, v105, v17
    s_branch k1_kernel_stat_done
k1_kernel_stat1:
    s_waitcnt lgkmcnt(0)
    v_mfma_f32_32x32x16_bf16 a[0:15], v[22:25], v[106:109], 0
    v_dot2_f32_bf16 v14, v106, v106, 0
    v_dot2_f32_bf16 v15, v107, v107, 0
    v_dot2_f32_bf16 v16, v108, v108, 0
    v_dot2_f32_bf16 v17, v109, v109, 0
    v_mfma_f32_32x32x16_bf16 a[0:15], v[22:25], v[110:113], a[0:15]
    v_dot2_f32_bf16 v14, v110, v110, v14
    v_dot2_f32_bf16 v15, v111, v111, v15
    v_dot2_f32_bf16 v16, v112, v112, v16
    v_dot2_f32_bf16 v17, v113, v113, v17
    v_mfma_f32_32x32x16_bf16 a[0:15], v[22:25], v[114:117], a[0:15]
    v_dot2_f32_bf16 v14, v114, v114, v14
    v_dot2_f32_bf16 v15, v115, v115, v15
    v_dot2_f32_bf16 v16, v116, v116, v16
    v_dot2_f32_bf16 v17, v117, v117, v17
    v_mfma_f32_32x32x16_bf16 a[0:15], v[22:25], v[118:121], a[0:15]
    v_dot2_f32_bf16 v14, v118, v118, v14
    v_dot2_f32_bf16 v15, v119, v119, v15
    v_dot2_f32_bf16 v16, v120, v120, v16
    v_dot2_f32_bf16 v17, v121, v121, v17
    v_mfma_f32_32x32x16_bf16 a[0:15], v[22:25], v[122:125], a[0:15]
    v_dot2_f32_bf16 v14, v122, v122, v14
    v_dot2_f32_bf16 v15, v123, v123, v15
    v_dot2_f32_bf16 v16, v124, v124, v16
    v_dot2_f32_bf16 v17, v125, v125, v17
    v_mfma_f32_32x32x16_bf16 a[0:15], v[22:25], v[126:129], a[0:15]
    v_dot2_f32_bf16 v14, v126, v126, v14
    v_dot2_f32_bf16 v15, v127, v127, v15
    v_dot2_f32_bf16 v16, v128, v128, v16
    v_dot2_f32_bf16 v17, v129, v129, v17
    v_mfma_f32_32x32x16_bf16 a[0:15], v[22:25], v[130:133], a[0:15]
    v_dot2_f32_bf16 v14, v130, v130, v14
    v_dot2_f32_bf16 v15, v131, v131, v15
    v_dot2_f32_bf16 v16, v132, v132, v16
    v_dot2_f32_bf16 v17, v133, v133, v17
    v_mfma_f32_32x32x16_bf16 a[0:15], v[22:25], v[134:137], a[0:15]
    v_dot2_f32_bf16 v14, v134, v134, v14
    v_dot2_f32_bf16 v15, v135, v135, v15
    v_dot2_f32_bf16 v16, v136, v136, v16
    v_dot2_f32_bf16 v17, v137, v137, v17
    v_mfma_f32_32x32x16_bf16 a[0:15], v[22:25], v[138:141], a[0:15]
    v_dot2_f32_bf16 v14, v138, v138, v14
    v_dot2_f32_bf16 v15, v139, v139, v15
    v_dot2_f32_bf16 v16, v140, v140, v16
    v_dot2_f32_bf16 v17, v141, v141, v17
    v_mfma_f32_32x32x16_bf16 a[0:15], v[22:25], v[142:145], a[0:15]
    v_dot2_f32_bf16 v14, v142, v142, v14
    v_dot2_f32_bf16 v15, v143, v143, v15
    v_dot2_f32_bf16 v16, v144, v144, v16
    v_dot2_f32_bf16 v17, v145, v145, v17
    v_mfma_f32_32x32x16_bf16 a[0:15], v[22:25], v[146:149], a[0:15]
    v_dot2_f32_bf16 v14, v146, v146, v14
    v_dot2_f32_bf16 v15, v147, v147, v15
    v_dot2_f32_bf16 v16, v148, v148, v16
    v_dot2_f32_bf16 v17, v149, v149, v17
    v_mfma_f32_32x32x16_bf16 a[0:15], v[22:25], v[150:153], a[0:15]
    v_dot2_f32_bf16 v14, v150, v150, v14
    v_dot2_f32_bf16 v15, v151, v151, v15
    v_dot2_f32_bf16 v16, v152, v152, v16
    v_dot2_f32_bf16 v17, v153, v153, v17
    v_mfma_f32_32x32x16_bf16 a[0:15], v[22:25], v[154:157], a[0:15]
    v_dot2_f32_bf16 v14, v154, v154, v14
    v_dot2_f32_bf16 v15, v155, v155, v15
    v_dot2_f32_bf16 v16, v156, v156, v16
    v_dot2_f32_bf16 v17, v157, v157, v17
    v_mfma_f32_32x32x16_bf16 a[0:15], v[22:25], v[158:161], a[0:15]
    v_dot2_f32_bf16 v14, v158, v158, v14
    v_dot2_f32_bf16 v15, v159, v159, v15
    v_dot2_f32_bf16 v16, v160, v160, v16
    v_dot2_f32_bf16 v17, v161, v161, v17
    v_mfma_f32_32x32x16_bf16 a[0:15], v[22:25], v[162:165], a[0:15]
    v_dot2_f32_bf16 v14, v162, v162, v14
    v_dot2_f32_bf16 v15, v163, v163, v15
    v_dot2_f32_bf16 v16, v164, v164, v16
    v_dot2_f32_bf16 v17, v165, v165, v17
    v_mfma_f32_32x32x16_bf16 a[0:15], v[22:25], v[166:169], a[0:15]
    v_dot2_f32_bf16 v14, v166, v166, v14
    v_dot2_f32_bf16 v15, v167, v167, v15
    v_dot2_f32_bf16 v16, v168, v168, v16
    v_dot2_f32_bf16 v17, v169, v169, v17
k1_kernel_stat_done:
    s_lshl_b32 s54, s6, 9
    s_lshl_b32 s55, s7, 8
    s_add_u32 s56, s54, s55
    s_xor_b32 s55, s55, 256
    s_add_u32 s54, s54, s55
    v_and_b32 v172, 31, v1
    v_lshlrev_b32 v172, 3, v172
    v_add_u32 v172, 154880, v172
    v_add_u32 v173, s54, v172
    v_add_u32 v172, s56, v172
    s_nop 3
    v_add_f32 v14, v14, v15
    v_add_f32 v16, v16, v17
    s_nop 0
    v_add_f32 v14, v14, v16
    s_nop 0
    v_mov_b32 v15, v14
    s_nop 1
    v_permlane32_swap_b32 v14, v15
    s_nop 1
    v_add_f32 v15, v14, v15
    v_accvgpr_read_b32 v14, a0
    s_nop 0
    ds_write_b64 v172, v[14:15]
    s_waitcnt lgkmcnt(0)
    s_barrier
    ds_read_b64 v[16:17], v173
    s_add_u32 m0, s36, 0
    s_nop 0
    buffer_load_dwordx4 v5, s[24:27], s60 offen lds
    s_add_u32 s60, s60, s64
    s_add_u32 m0, s37, 0
    s_nop 0
    buffer_load_dwordx4 v6, s[28:31], s61 offen lds
    s_add_u32 s61, s61, s65
    s_add_u32 s57, s38, 0
    s_cmp_eq_u32 s75, 1
    s_cselect_b32 m0, 153856, s57
    s_nop 0
    buffer_load_dwordx4 v7, s[32:35], s62 offen lds
    s_add_u32 s62, s62, s66
    s_add_u32 m0, s36, 20736
    s_nop 0
    buffer_load_dwordx4 v5, s[24:27], s60 offen lds
    s_add_u32 s60, s60, s64
    s_add_u32 m0, s37, 20736
    s_nop 0
    buffer_load_dwordx4 v6, s[28:31], s61 offen lds
    s_add_u32 s61, s61, s65
    s_add_u32 s57, s38, 20736
    s_cmp_eq_u32 s75, 1
    s_cselect_b32 m0, 153856, s57
    s_nop 0
    buffer_load_dwordx4 v7, s[32:35], s62 offen lds
    s_add_u32 s62, s62, s66
    s_waitcnt lgkmcnt(0)
    v_add_f32 v18, v14, v16
    v_add_f32 v14, v15, v17
    v_mul_f32 v18, 0x3b000000, v18
    v_mul_f32 v14, 0x3b000000, v14
    v_fma_f32 v14, -v18, v18, v14
    v_max_f32 v14, 0, v14
    v_cvt_pk_bf16_f32 v20, v18, v14
    v_lshlrev_b32 v18, 16, v20
    v_and_b32 v14, s68, v20
    v_add_f32 v14, 0x3727c5ac, v14
    v_cvt_pk_bf16_f32 v14, v14, v14
    v_and_b32 v14, s68, v14
    v_sqrt_f32 v14, v14
    s_nop 0
    v_cvt_pk_bf16_f32 v14, v14, v14
    v_and_b32 v14, s68, v14
    v_rcp_f32 v12, v14
    s_nop 0
    v_mul_f32 v13, -v18, v12
    v_lshlrev_b32 v14, 16, v42
    v_and_b32 v15, s68, v42
    v_lshlrev_b32 v16, 16, v43
    v_and_b32 v17, s68, v43
    v_lshlrev_b32 v18, 16, v44
    v_and_b32 v19, s68, v44
    v_lshlrev_b32 v20, 16, v45
    v_and_b32 v21, s68, v45
    v_fma_f32 v14, v14, v12, v13
    v_fma_f32 v15, v15, v12, v13
    v_fma_f32 v16, v16, v12, v13
    v_fma_f32 v17, v17, v12, v13
    v_fma_f32 v18, v18, v12, v13
    v_fma_f32 v19, v19, v12, v13
    v_fma_f32 v20, v20, v12, v13
    v_fma_f32 v21, v21, v12, v13
    v_cvt_pk_bf16_f32 v42, v14, v15
    v_cvt_pk_bf16_f32 v43, v16, v17
    v_cvt_pk_bf16_f32 v44, v18, v19
    v_cvt_pk_bf16_f32 v45, v20, v21
    s_mul_i32 s70, s59, 112
    s_mul_i32 s54, s5, 7
    s_add_u32 s70, s70, s54
    s_lshl_b32 s70, s70, 10
    s_add_u32 s70, s70, 16777216
    s_add_u32 s71, s70, 4096
    v_lshrrev_b32 v170, 2, v1
    v_lshlrev_b32 v170, 10, v170
    v_and_b32 v171, 3, v1
    v_lshl_add_u32 v170, v171, 4, v170
    v_lshlrev_b32 v171, 3, v171
    v_bfe_u32 v172, v1, 2, 2
    v_lshl_add_u32 v171, v172, 6, v171
    v_bfe_u32 v172, v1, 4, 1
    v_lshl_add_u32 v171, v172, 5, v171
    v_lshrrev_b32 v172, 5, v1
    v_lshl_add_u32 v171, v172, 8, v171
    s_lshl_b32 s74, s3, 10
    s_add_u32 s74, s74, 124416
    v_add_u32 v171, s74, v171
    s_lshl_b32 s73, s2, 3
    s_add_u32 s73, s73, s3
    s_cmp_lt_u32 s73, 256
    s_mov_b32 s20, s12
    s_mov_b32 s21, s13
    s_cselect_b32 s22, 33554432, 0
    s_mov_b32 s23, 0x00020000
    s_cmp_eq_u32 s7, 1
    s_cbranch_scc1 k1_kernel_main1
    s_waitcnt vmcnt(6)
    s_barrier
    v_add_u32 v10, 133120, v8
    v_add_u32 v11, 133120, v9
    ds_read_b64_tr_b16 v[22:23], v11 offset:0
    ds_read_b64_tr_b16 v[24:25], v11 offset:256
    ds_read_b64_tr_b16 v[26:27], v11 offset:2048
    ds_read_b64_tr_b16 v[28:29], v11 offset:2304
    ds_read_b64_tr_b16 v[30:31], v11 offset:4096
    ds_read_b64_tr_b16 v[32:33], v11 offset:4352
    ds_read_b64_tr_b16 v[34:35], v10 offset:0
    ds_read_b64_tr_b16 v[36:37], v10 offset:896
    ds_read_b64_tr_b16 v[38:39], v10 offset:32
    ds_read_b64_tr_b16 v[40:41], v10 offset:928
    s_waitcnt lgkmcnt(8)
    v_mfma_f32_32x32x16_bf16 a[0:15], v[22:25], v[42:45], 0
    ds_read_b64_tr_b16 v[22:23], v11 offset:512
    ds_read_b64_tr_b16 v[24:25], v11 offset:768
    s_add_u32 m0, s36, 41472
    s_nop 0
    buffer_load_dwordx4 v5, s[24:27], s60 offen lds
    s_add_u32 s60, s60, s64
    v_lshlrev_b32 v14, 16, v46
    v_and_b32 v15, s68, v46
    v_lshlrev_b32 v16, 16, v47
    v_and_b32 v17, s68, v47
    v_lshlrev_b32 v18, 16, v48
    s_waitcnt lgkmcnt(8)
    v_mfma_f32_32x32x16_bf16 a[16:31], v[26:29], v[42:45], 0
    ds_read_b64_tr_b16 v[26:27], v11 offset:2560
    ds_read_b64_tr_b16 v[28:29], v11 offset:2816
    s_add_u32 m0, s37, 41472
    s_nop 0
    buffer_load_dwordx4 v6, s[28:31], s61 offen lds
    s_add_u32 s61, s61, s65
    v_and_b32 v19, s68, v48
    v_lshlrev_b32 v20, 16, v49
    v_and_b32 v21, s68, v49
    v_fma_f32 v14, v14, v12, v13
    v_fma_f32 v15, v15, v12, v13
    s_waitcnt lgkmcnt(8)
    v_mfma_f32_32x32x16_bf16 a[32:47], v[42:45], v[30:33], 0
    ds_read_b64_tr_b16 v[30:31], v11 offset:4608
    ds_read_b64_tr_b16 v[32:33], v11 offset:4864
    s_add_u32 s57, s38, 41472
    s_cmp_eq_u32 s75, 1
    s_cselect_b32 m0, 153856, s57
    s_nop 0
    buffer_load_dwordx4 v7, s[32:35], s62 offen lds
    s_add_u32 s62, s62, s66
    v_fma_f32 v16, v16, v12, v13
    v_fma_f32 v17, v17, v12, v13
    v_fma_f32 v18, v18, v12, v13
    v_fma_f32 v19, v19, v12, v13
    v_fma_f32 v20, v20, v12, v13
    s_waitcnt lgkmcnt(8)
    v_mfma_f32_32x32x16_bf16 a[48:63], v[34:37], v[42:45], 0
    ds_read_b64_tr_b16 v[34:35], v10 offset:1792
    ds_read_b64_tr_b16 v[36:37], v10 offset:2688
    v_fma_f32 v21, v21, v12, v13
    v_cvt_pk_bf16_f32 v46, v14, v15
    v_cvt_pk_bf16_f32 v47, v16, v17
    v_cvt_pk_bf16_f32 v48, v18, v19
    v_cvt_pk_bf16_f32 v49, v20, v21
    s_waitcnt lgkmcnt(8)
    v_mfma_f32_32x32x16_bf16 a[64:79], v[38:41], v[42:45], 0
    ds_read_b64_tr_b16 v[38:39], v10 offset:1824
    ds_read_b64_tr_b16 v[40:41], v10 offset:2720
    s_waitcnt vmcnt(6)
    s_barrier
    v_add_u32 v10, 0, v8
    v_add_u32 v11, 0, v9
    s_waitcnt lgkmcnt(8)
    v_mfma_f32_32x32x16_bf16 a[0:15], v[22:25], v[46:49], a[0:15]
    ds_read_b64_tr_b16 v[22:23], v11 offset:0
    ds_read_b64_tr_b16 v[24:25], v11 offset:256
    s_add_u32 m0, s36, 62208
    s_nop 0
    buffer_load_dwordx4 v5, s[24:27], s60 offen lds
    s_add_u32 s60, s60, s64
    v_lshlrev_b32 v14, 16, v50
    v_and_b32 v15, s68, v50
    v_lshlrev_b32 v16, 16, v51
    v_and_b32 v17, s68, v51
    v_lshlrev_b32 v18, 16, v52
    s_waitcnt lgkmcnt(8)
    v_mfma_f32_32x32x16_bf16 a[16:31], v[26:29], v[46:49], a[16:31]
    ds_read_b64_tr_b16 v[26:27], v11 offset:2048
    ds_read_b64_tr_b16 v[28:29], v11 offset:2304
    s_add_u32 m0, s37, 62208
    s_nop 0
    buffer_load_dwordx4 v6, s[28:31], s61 offen lds
    s_add_u32 s61, s61, s65
    v_and_b32 v19, s68, v52
    v_lshlrev_b32 v20, 16, v53
    v_and_b32 v21, s68, v53
    v_fma_f32 v14, v14, v12, v13
    v_fma_f32 v15, v15, v12, v13
    s_waitcnt lgkmcnt(8)
    v_mfma_f32_32x32x16_bf16 a[32:47], v[46:49], v[30:33], a[32:47]
    ds_read_b64_tr_b16 v[30:31], v11 offset:4096
    ds_read_b64_tr_b16 v[32:33], v11 offset:4352
    s_add_u32 s57, s38, 62208
    s_cmp_eq_u32 s75, 1
    s_cselect_b32 m0, 153856, s57
    s_nop 0
    buffer_load_dwordx4 v7, s[32:35], s62 offen lds
    s_add_u32 s62, s62, s66
    v_fma_f32 v16, v16, v12, v13
    v_fma_f32 v17, v17, v12, v13
    v_fma_f32 v18, v18, v12, v13
    v_fma_f32 v19, v19, v12, v13
    v_fma_f32 v20, v20, v12, v13
    s_waitcnt lgkmcnt(8)
    v_mfma_f32_32x32x16_bf16 a[48:63], v[34:37], v[46:49], a[48:63]
    ds_read_b64_tr_b16 v[34:35], v10 offset:0
    ds_read_b64_tr_b16 v[36:37], v10 offset:896
    v_fma_f32 v21, v21, v12, v13
    v_cvt_pk_bf16_f32 v50, v14, v15
    v_cvt_pk_bf16_f32 v51, v16, v17
    v_cvt_pk_bf16_f32 v52, v18, v19
    v_cvt_pk_bf16_f32 v53, v20, v21
    s_waitcnt lgkmcnt(8)
    v_mfma_f32_32x32x16_bf16 a[64:79], v[38:41], v[46:49], a[64:79]
    ds_read_b64_tr_b16 v[38:39], v10 offset:32
    ds_read_b64_tr_b16 v[40:41], v10 offset:928
    s_waitcnt lgkmcnt(8)
    v_mfma_f32_32x32x16_bf16 a[0:15], v[22:25], v[50:53], a[0:15]
    ds_read_b64_tr_b16 v[22:23], v11 offset:512
    ds_read_b64_tr_b16 v[24:25], v11 offset:768
    s_add_u32 m0, s36, 82944
    s_nop 0
    buffer_load_dwordx4 v5, s[24:27], s60 offen lds
    s_add_u32 s60, s60, s64
    v_lshlrev_b32 v14, 16, v54
    v_and_b32 v15, s68, v54
    v_lshlrev_b32 v16, 16, v55
    v_and_b32 v17, s68, v55
    v_lshlrev_b32 v18, 16, v56
    s_waitcnt lgkmcnt(8)
    v_mfma_f32_32x32x16_bf16 a[16:31], v[26:29], v[50:53], a[16:31]
    ds_read_b64_tr_b16 v[26:27], v11 offset:2560
    ds_read_b64_tr_b16 v[28:29], v11 offset:2816
    s_add_u32 m0, s37, 82944
    s_nop 0
    buffer_load_dwordx4 v6, s[28:31], s61 offen lds
    s_add_u32 s61, s61, s65
    v_and_b32 v19, s68, v56
    v_lshlrev_b32 v20, 16, v57
    v_and_b32 v21, s68, v57
    v_fma_f32 v14, v14, v12, v13
    v_fma_f32 v15, v15, v12, v13
    s_waitcnt lgkmcnt(8)
    v_mfma_f32_32x32x16_bf16 a[32:47], v[50:53], v[30:33], a[32:47]
    ds_read_b64_tr_b16 v[30:31], v11 offset:4608
    ds_read_b64_tr_b16 v[32:33], v11 offset:4864
    s_add_u32 s57, s38, 82944
    s_cmp_eq_u32 s75, 1
    s_cselect_b32 m0, 153856, s57
    s_nop 0
    buffer_load_dwordx4 v7, s[32:35], s62 offen lds
    s_add_u32 s62, s62, s66
    v_fma_f32 v16, v16, v12, v13
    v_fma_f32 v17, v17, v12, v13
    v_fma_f32 v18, v18, v12, v13
    v_fma_f32 v19, v19, v12, v13
    v_fma_f32 v20, v20, v12, v13
    s_waitcnt lgkmcnt(8)
    v_mfma_f32_32x32x16_bf16 a[48:63], v[34:37], v[50:53], a[48:63]
    ds_read_b64_tr_b16 v[34:35], v10 offset:1792
    ds_read_b64_tr_b16 v[36:37], v10 offset:2688
    v_fma_f32 v21, v21, v12, v13
    v_cvt_pk_bf16_f32 v54, v14, v15
    v_cvt_pk_bf16_f32 v55, v16, v17
    v_cvt_pk_bf16_f32 v56, v18, v19
    v_cvt_pk_bf16_f32 v57, v20, v21
    s_waitcnt lgkmcnt(8)
    v_mfma_f32_32x32x16_bf16 a[64:79], v[38:41], v[50:53], a[64:79]
    ds_read_b64_tr_b16 v[38:39], v10 offset:1824
    ds_read_b64_tr_b16 v[40:41], v10 offset:2720
    s_waitcnt vmcnt(9)
    s_barrier
    v_add_u32 v10, 20736, v8
    v_add_u32 v11, 20736, v9
    s_waitcnt lgkmcnt(8)
    v_mfma_f32_32x32x16_bf16 a[0:15], v[22:25], v[54:57], a[0:15]
    ds_read_b64_tr_b16 v[22:23], v11 offset:0
    ds_read_b64_tr_b16 v[24:25], v11 offset:256
    s_add_u32 m0, s36, 103680
    s_nop 0
    buffer_load_dwordx4 v5, s[24:27], s60 offen lds
    s_add_u32 s60, s60, s64
    s_add_u32 m0, s37, 103680
    s_nop 0
    buffer_load_dwordx4 v6, s[28:31], s61 offen lds
    s_add_u32 s61, s61, s65
    v_lshlrev_b32 v14, 16, v58
    v_and_b32 v15, s68, v58
    v_lshlrev_b32 v16, 16, v59
    v_and_b32 v17, s68, v59
    v_lshlrev_b32 v18, 16, v60
    s_waitcnt lgkmcnt(8)
    v_mfma_f32_32x32x16_bf16 a[16:31], v[26:29], v[54:57], a[16:31]
    ds_read_b64_tr_b16 v[26:27], v11 offset:2048
    ds_read_b64_tr_b16 v[28:29], v11 offset:2304
    s_add_u32 s57, s38, 103680
    s_cmp_eq_u32 s75, 1
    s_cselect_b32 m0, 153856, s57
    s_nop 0
    buffer_load_dwordx4 v7, s[32:35], s62 offen lds
    s_add_u32 s62, s62, s66
    v_and_b32 v19, s68, v60
    v_lshlrev_b32 v20, 16, v61
    v_and_b32 v21, s68, v61
    v_fma_f32 v14, v14, v12, v13
    v_fma_f32 v15, v15, v12, v13
    s_waitcnt lgkmcnt(8)
    v_mfma_f32_32x32x16_bf16 a[32:47], v[54:57], v[30:33], a[32:47]
    ds_read_b64_tr_b16 v[30:31], v11 offset:4096
    ds_read_b64_tr_b16 v[32:33], v11 offset:4352
    s_add_u32 m0, s36, 133120
    s_nop 0
    buffer_load_dwordx4 v5, s[24:27], s60 offen lds
    s_add_u32 s60, s60, s64
    v_fma_f32 v16, v16, v12, v13
    v_fma_f32 v17, v17, v12, v13
    v_fma_f32 v18, v18, v12, v13
    v_fma_f32 v19, v19, v12, v13
    v_fma_f32 v20, v20, v12, v13
    s_waitcnt lgkmcnt(8)
    v_mfma_f32_32x32x16_bf16 a[48:63], v[34:37], v[54:57], a[48:63]
    ds_read_b64_tr_b16 v[34:35], v10 offset:0
    ds_read_b64_tr_b16 v[36:37], v10 offset:896
    s_add_u32 m0, s37, 133120
    s_nop 0
    buffer_load_dwordx4 v6, s[28:31], s61 offen lds
    s_add_u32 s61, s61, s65
    v_fma_f32 v21, v21, v12, v13
    v_cvt_pk_bf16_f32 v58, v14, v15
    v_cvt_pk_bf16_f32 v59, v16, v17
    v_cvt_pk_bf16_f32 v60, v18, v19
    v_cvt_pk_bf16_f32 v61, v20, v21
    s_waitcnt lgkmcnt(8)
    v_mfma_f32_32x32x16_bf16 a[64:79], v[38:41], v[54:57], a[64:79]
    ds_read_b64_tr_b16 v[38:39], v10 offset:32
    ds_read_b64_tr_b16 v[40:41], v10 offset:928
    s_add_u32 s57, s38, 133120
    s_cmp_eq_u32 s75, 1
    s_cselect_b32 m0, 153856, s57
    s_nop 0
    buffer_load_dwordx4 v7, s[32:35], s62 offen lds
    s_add_u32 s62, s62, s66
    s_waitcnt lgkmcnt(8)
    v_mfma_f32_32x32x16_bf16 a[0:15], v[22:25], v[58:61], a[0:15]
    ds_read_b64_tr_b16 v[22:23], v11 offset:512
    ds_read_b64_tr_b16 v[24:25], v11 offset:768
    v_lshlrev_b32 v14, 16, v62
    v_and_b32 v15, s68, v62
    v_lshlrev_b32 v16, 16, v63
    v_and_b32 v17, s68, v63
    v_lshlrev_b32 v18, 16, v64
    s_waitcnt lgkmcnt(8)
    v_mfma_f32_32x32x16_bf16 a[16:31], v[26:29], v[58:61], a[16:31]
    ds_read_b64_tr_b16 v[26:27], v11 offset:2560
    ds_read_b64_tr_b16 v[28:29], v11 offset:2816
    v_and_b32 v19, s68, v64
    v_lshlrev_b32 v20, 16, v65
    v_and_b32 v21, s68, v65
    v_fma_f32 v14, v14, v12, v13
    v_fma_f32 v15, v15, v12, v13
    s_waitcnt lgkmcnt(8)
    v_mfma_f32_32x32x16_bf16 a[32:47], v[58:61], v[30:33], a[32:47]
    ds_read_b64_tr_b16 v[30:31], v11 offset:4608
    ds_read_b64_tr_b16 v[32:33], v11 offset:4864
    v_fma_f32 v16, v16, v12, v13
    v_fma_f32 v17, v17, v12, v13
    v_fma_f32 v18, v18, v12, v13
    v_fma_f32 v19, v19, v12, v13
    v_fma_f32 v20, v20, v12, v13
    s_waitcnt lgkmcnt(8)
    v_mfma_f32_32x32x16_bf16 a[48:63], v[34:37], v[58:61], a[48:63]
    ds_read_b64_tr_b16 v[34:35], v10 offset:1792
    ds_read_b64_tr_b16 v[36:37], v10 offset:2688
    v_fma_f32 v21, v21, v12, v13
    v_cvt_pk_bf16_f32 v62, v14, v15
    v_cvt_pk_bf16_f32 v63, v16, v17
    v_cvt_pk_bf16_f32 v64, v18, v19
    v_cvt_pk_bf16_f32 v65, v20, v21
    s_waitcnt lgkmcnt(8)
    v_mfma_f32_32x32x16_bf16 a[64:79], v[38:41], v[58:61], a[64:79]
    ds_read_b64_tr_b16 v[38:39], v10 offset:1824
    ds_read_b64_tr_b16 v[40:41], v10 offset:2720
    s_waitcnt vmcnt(12)
    s_barrier
    v_add_u32 v10, 41472, v8
    v_add_u32 v11, 41472, v9
    s_waitcnt lgkmcnt(8)
    v_mfma_f32_32x32x16_bf16 a[0:15], v[22:25], v[62:65], a[0:15]
    ds_read_b64_tr_b16 v[22:23], v11 offset:0
    ds_read_b64_tr_b16 v[24:25], v11 offset:256
    s_add_u32 m0, s36, 0
    s_nop 0
    buffer_load_dwordx4 v5, s[24:27], s60 offen lds
    s_add_u32 s60, s60, s64
    v_lshlrev_b32 v14, 16, v66
    v_and_b32 v15, s68, v66
    v_lshlrev_b32 v16, 16, v67
    v_and_b32 v17, s68, v67
    v_lshlrev_b32 v18, 16, v68
    s_waitcnt lgkmcnt(8)
    v_mfma_f32_32x32x16_bf16 a[16:31], v[26:29], v[62:65], a[16:31]
    ds_read_b64_tr_b16 v[26:27], v11 offset:2048
    ds_read_b64_tr_b16 v[28:29], v11 offset:2304
    s_add_u32 m0, s37, 0
    s_nop 0
    buffer_load_dwordx4 v6, s[28:31], s61 offen lds
    s_add_u32 s61, s61, s65
    v_and_b32 v19, s68, v68
    v_lshlrev_b32 v20, 16, v69
    v_and_b32 v21, s68, v69
    v_fma_f32 v14, v14, v12, v13
    v_fma_f32 v15, v15, v12, v13
    s_waitcnt lgkmcnt(8)
    v_mfma_f32_32x32x16_bf16 a[32:47], v[62:65], v[30:33], a[32:47]
    ds_read_b64_tr_b16 v[30:31], v11 offset:4096
    ds_read_b64_tr_b16 v[32:33], v11 offset:4352
    s_add_u32 s57, s38, 0
    s_cmp_eq_u32 s75, 1
    s_cselect_b32 m0, 153856, s57
    s_nop 0
    buffer_load_dwordx4 v7, s[32:35], s62 offen lds
    s_add_u32 s62, s62, s66
    v_fma_f32 v16, v16, v12, v13
    v_fma_f32 v17, v17, v12, v13
    v_fma_f32 v18, v18, v12, v13
    v_fma_f32 v19, v19, v12, v13
    v_fma_f32 v20, v20, v12, v13
    s_waitcnt lgkmcnt(8)
    v_mfma_f32_32x32x16_bf16 a[48:63], v[34:37], v[62:65], a[48:63]
    ds_read_b64_tr_b16 v[34:35], v10 offset:0
    ds_read_b64_tr_b16 v[36:37], v10 offset:896
    v_fma_f32 v21, v21, v12, v13
    v_cvt_pk_bf16_f32 v66, v14, v15
    v_cvt_pk_bf16_f32 v67, v16, v17
    v_cvt_pk_bf16_f32 v68, v18, v19
    v_cvt_pk_bf16_f32 v69, v20, v21
    s_waitcnt lgkmcnt(8)
    v_mfma_f32_32x32x16_bf16 a[64:79], v[38:41], v[62:65], a[64:79]
    ds_read_b64_tr_b16 v[38:39], v10 offset:32
    ds_read_b64_tr_b16 v[40:41], v10 offset:928
    s_waitcnt lgkmcnt(8)
    v_mfma_f32_32x32x16_bf16 a[0:15], v[22:25], v[66:69], a[0:15]
    ds_read_b64_tr_b16 v[22:23], v11 offset:512
    ds_read_b64_tr_b16 v[24:25], v11 offset:768
    v_lshlrev_b32 v14, 16, v70
    v_and_b32 v15, s68, v70
    v_lshlrev_b32 v16, 16, v71
    v_and_b32 v17, s68, v71
    v_lshlrev_b32 v18, 16, v72
    s_waitcnt lgkmcnt(8)
    v_mfma_f32_32x32x16_bf16 a[16:31], v[26:29], v[66:69], a[16:31]
    ds_read_b64_tr_b16 v[26:27], v11 offset:2560
    ds_read_b64_tr_b16 v[28:29], v11 offset:2816
    v_and_b32 v19, s68, v72
    v_lshlrev_b32 v20, 16, v73
    v_and_b32 v21, s68, v73
    v_fma_f32 v14, v14, v12, v13
    v_fma_f32 v15, v15, v12, v13
    s_waitcnt lgkmcnt(8)
    v_mfma_f32_32x32x16_bf16 a[32:47], v[66:69], v[30:33], a[32:47]
    ds_read_b64_tr_b16 v[30:31], v11 offset:4608
    ds_read_b64_tr_b16 v[32:33], v11 offset:4864
    v_fma_f32 v16, v16, v12, v13
    v_fma_f32 v17, v17, v12, v13
    v_fma_f32 v18, v18, v12, v13
    v_fma_f32 v19, v19, v12, v13
    v_fma_f32 v20, v20, v12, v13
    s_waitcnt lgkmcnt(8)
    v_mfma_f32_32x32x16_bf16 a[48:63], v[34:37], v[66:69], a[48:63]
    ds_read_b64_tr_b16 v[34:35], v10 offset:1792
    ds_read_b64_tr_b16 v[36:37], v10 offset:2688
    v_fma_f32 v21, v21, v12, v13
    v_cvt_pk_bf16_f32 v70, v14, v15
    v_cvt_pk_bf16_f32 v71, v16, v17
    v_cvt_pk_bf16_f32 v72, v18, v19
    v_cvt_pk_bf16_f32 v73, v20, v21
    s_waitcnt lgkmcnt(8)
    v_mfma_f32_32x32x16_bf16 a[64:79], v[38:41], v[66:69], a[64:79]
    ds_read_b64_tr_b16 v[38:39], v10 offset:1824
    ds_read_b64_tr_b16 v[40:41], v10 offset:2720
    s_waitcnt vmcnt(12)
    s_barrier
    v_add_u32 v10, 62208, v8
    v_add_u32 v11, 62208, v9
    s_waitcnt lgkmcnt(8)
    v_mfma_f32_32x32x16_bf16 a[0:15], v[22:25], v[70:73], a[0:15]
    ds_read_b64_tr_b16 v[22:23], v11 offset:0
    ds_read_b64_tr_b16 v[24:25], v11 offset:256
    s_add_u32 m0, s36, 20736
    s_nop 0
    buffer_load_dwordx4 v5, s[24:27], s60 offen lds
    s_add_u32 s60, s60, s64
    v_lshlrev_b32 v14, 16, v74
    v_and_b32 v15, s68, v74
    v_lshlrev_b32 v16, 16, v75
    v_and_b32 v17, s68, v75
    v_lshlrev_b32 v18, 16, v76
    s_waitcnt lgkmcnt(8)
    v_mfma_f32_32x32x16_bf16 a[16:31], v[26:29], v[70:73], a[16:31]
    ds_read_b64_tr_b16 v[26:27], v11 offset:2048
    ds_read_b64_tr_b16 v[28:29], v11 offset:2304
    s_add_u32 m0, s37, 20736
    s_nop 0
    buffer_load_dwordx4 v6, s[28:31], s61 offen lds
    s_add_u32 s61, s61, s65
    v_and_b32 v19, s68, v76
    v_lshlrev_b32 v20, 16, v77
    v_and_b32 v21, s68, v77
    v_fma_f32 v14, v14, v12, v13
    v_fma_f32 v15, v15, v12, v13
    s_waitcnt lgkmcnt(8)
    v_mfma_f32_32x32x16_bf16 a[32:47], v[70:73], v[30:33], a[32:47]
    ds_read_b64_tr_b16 v[30:31], v11 offset:4096
    ds_read_b64_tr_b16 v[32:33], v11 offset:4352
    s_add_u32 s57, s38, 20736
    s_cmp_eq_u32 s75, 1
    s_cselect_b32 m0, 153856, s57
    s_nop 0
    buffer_load_dwordx4 v7, s[32:35], s62 offen lds
    s_add_u32 s62, s62, s66
    v_fma_f32 v16, v16, v12, v13
    v_fma_f32 v17, v17, v12, v13
    v_fma_f32 v18, v18, v12, v13
    v_fma_f32 v19, v19, v12, v13
    v_fma_f32 v20, v20, v12, v13
    s_waitcnt lgkmcnt(8)
    v_mfma_f32_32x32x16_bf16 a[48:63], v[34:37], v[70:73], a[48:63]
    ds_read_b64_tr_b16 v[34:35], v10 offset:0
    ds_read_b64_tr_b16 v[36:37], v10 offset:896
    v_fma_f32 v21, v21, v12, v13
    v_cvt_pk_bf16_f32 v74, v14, v15
    v_cvt_pk_bf16_f32 v75, v16, v17
    v_cvt_pk_bf16_f32 v76, v18, v19
    v_cvt_pk_bf16_f32 v77, v20, v21
    s_waitcnt lgkmcnt(8)
    v_mfma_f32_32x32x16_bf16 a[64:79], v[38:41], v[70:73], a[64:79]
    ds_read_b64_tr_b16 v[38:39], v10 offset:32
    ds_read_b64_tr_b16 v[40:41], v10 offset:928
    s_add_u32 s55, s73, 0
    s_lshr_b32 s56, s55, 4
    s_and_b32 s55, s55, 15
    s_mul_i32 s72, s55, 144
    s_add_u32 s72, s72, s56
    s_lshl_b32 s72, s72, 10
    s_add_u32 s72, s72, 10485760
    s_mov_b32 s18, 524288
    s_cmp_lt_u32 s56, 112
    s_cselect_b32 s16, s50, s48
    s_cselect_b32 s17, s51, s49
    s_cselect_b32 s18, 1835008, s18
    s_cselect_b32 s54, 0, 112
    s_and_b32 s17, s17, 0xffff
    s_mov_b32 s19, 0x00020000
    s_sub_u32 s56, s56, s54
    s_lshl_b32 s56, s56, 14
    s_mov_b32 m0, s74
    s_lshl_b32 s55, s55, 6
    s_add_u32 s56, s56, s55
    buffer_load_dwordx4 v170, s[16:19], s56 offen lds
    s_waitcnt lgkmcnt(8)
    v_mfma_f32_32x32x16_bf16 a[0:15], v[22:25], v[74:77], a[0:15]
    ds_read_b64_tr_b16 v[22:23], v11 offset:512
    ds_read_b64_tr_b16 v[24:25], v11 offset:768
    v_lshlrev_b32 v14, 16, v78
    v_and_b32 v15, s68, v78
    v_lshlrev_b32 v16, 16, v79
    v_and_b32 v17, s68, v79
    v_lshlrev_b32 v18, 16, v80
    s_waitcnt lgkmcnt(8)
    v_mfma_f32_32x32x16_bf16 a[16:31], v[26:29], v[74:77], a[16:31]
    ds_read_b64_tr_b16 v[26:27], v11 offset:2560
    ds_read_b64_tr_b16 v[28:29], v11 offset:2816
    v_and_b32 v19, s68, v80
    v_lshlrev_b32 v20, 16, v81
    v_and_b32 v21, s68, v81
    v_fma_f32 v14, v14, v12, v13
    v_fma_f32 v15, v15, v12, v13
    s_waitcnt lgkmcnt(8)
    v_mfma_f32_32x32x16_bf16 a[32:47], v[74:77], v[30:33], a[32:47]
    ds_read_b64_tr_b16 v[30:31], v11 offset:4608
    ds_read_b64_tr_b16 v[32:33], v11 offset:4864
    v_fma_f32 v16, v16, v12, v13
    v_fma_f32 v17, v17, v12, v13
    v_fma_f32 v18, v18, v12, v13
    v_fma_f32 v19, v19, v12, v13
    v_fma_f32 v20, v20, v12, v13
    s_waitcnt lgkmcnt(8)
    v_mfma_f32_32x32x16_bf16 a[48:63], v[34:37], v[74:77], a[48:63]
    ds_read_b64_tr_b16 v[34:35], v10 offset:1792
    ds_read_b64_tr_b16 v[36:37], v10 offset:2688
    v_fma_f32 v21, v21, v12, v13
    v_cvt_pk_bf16_f32 v78, v14, v15
    v_cvt_pk_bf16_f32 v79, v16, v17
    v_cvt_pk_bf16_f32 v80, v18, v19
    v_cvt_pk_bf16_f32 v81, v20, v21
    s_waitcnt lgkmcnt(8)
    v_mfma_f32_32x32x16_bf16 a[64:79], v[38:41], v[74:77], a[64:79]
    ds_read_b64_tr_b16 v[38:39], v10 offset:1824
    ds_read_b64_tr_b16 v[40:41], v10 offset:2720
    s_waitcnt vmcnt(13)
    s_barrier
    v_add_u32 v10, 82944, v8
    v_add_u32 v11, 82944, v9
    s_waitcnt lgkmcnt(8)
    v_mfma_f32_32x32x16_bf16 a[0:15], v[22:25], v[78:81], a[0:15]
    ds_read_b64_tr_b16 v[22:23], v11 offset:0
    ds_read_b64_tr_b16 v[24:25], v11 offset:256
    s_add_u32 m0, s36, 41472
    s_nop 0
    buffer_load_dwordx4 v5, s[24:27], s60 offen lds
    s_add_u32 s60, s60, s64
    v_lshlrev_b32 v14, 16, v82
    v_and_b32 v15, s68, v82
    v_lshlrev_b32 v16, 16, v83
    v_and_b32 v17, s68, v83
    v_lshlrev_b32 v18, 16, v84
    s_waitcnt lgkmcnt(8)
    v_mfma_f32_32x32x16_bf16 a[16:31], v[26:29], v[78:81], a[16:31]
    ds_read_b64_tr_b16 v[26:27], v11 offset:2048
    ds_read_b64_tr_b16 v[28:29], v11 offset:2304
    s_add_u32 m0, s37, 41472
    s_nop 0
    buffer_load_dwordx4 v6, s[28:31], s61 offen lds
    s_add_u32 s61, s61, s65
    v_and_b32 v19, s68, v84
    v_lshlrev_b32 v20, 16, v85
    v_and_b32 v21, s68, v85
    v_fma_f32 v14, v14, v12, v13
    v_fma_f32 v15, v15, v12, v13
    s_waitcnt lgkmcnt(8)
    v_mfma_f32_32x32x16_bf16 a[32:47], v[78:81], v[30:33], a[32:47]
    ds_read_b64_tr_b16 v[30:31], v11 offset:4096
    ds_read_b64_tr_b16 v[32:33], v11 offset:4352
    s_add_u32 s57, s38, 41472
    s_cmp_eq_u32 s75, 1
    s_cselect_b32 m0, 153856, s57
    s_nop 0
    buffer_load_dwordx4 v7, s[32:35], s62 offen lds
    s_add_u32 s62, s62, s66
    v_fma_f32 v16, v16, v12, v13
    v_fma_f32 v17, v17, v12, v13
    v_fma_f32 v18, v18, v12, v13
    v_fma_f32 v19, v19, v12, v13
    v_fma_f32 v20, v20, v12, v13
    s_waitcnt lgkmcnt(8)
    v_mfma_f32_32x32x16_bf16 a[48:63], v[34:37], v[78:81], a[48:63]
    ds_read_b64_tr_b16 v[34:35], v10 offset:0
    ds_read_b64_tr_b16 v[36:37], v10 offset:896
    v_fma_f32 v21, v21, v12, v13
    v_cvt_pk_bf16_f32 v82, v14, v15
    v_cvt_pk_bf16_f32 v83, v16, v17
    v_cvt_pk_bf16_f32 v84, v18, v19
    v_cvt_pk_bf16_f32 v85, v20, v21
    s_waitcnt lgkmcnt(8)
    v_mfma_f32_32x32x16_bf16 a[64:79], v[38:41], v[78:81], a[64:79]
    ds_read_b64_tr_b16 v[38:39], v10 offset:32
    ds_read_b64_tr_b16 v[40:41], v10 offset:928
    s_waitcnt lgkmcnt(8)
    v_mfma_f32_32x32x16_bf16 a[0:15], v[22:25], v[82:85], a[0:15]
    ds_read_b64_tr_b16 v[22:23], v11 offset:512
    ds_read_b64_tr_b16 v[24:25], v11 offset:768
    v_lshlrev_b32 v14, 16, v86
    v_and_b32 v15, s68, v86
    v_lshlrev_b32 v16, 16, v87
    v_and_b32 v17, s68, v87
    v_lshlrev_b32 v18, 16, v88
    s_waitcnt lgkmcnt(8)
    v_mfma_f32_32x32x16_bf16 a[16:31], v[26:29], v[82:85], a[16:31]
    ds_read_b64_tr_b16 v[26:27], v11 offset:2560
    ds_read_b64_tr_b16 v[28:29], v11 offset:2816
    v_and_b32 v19, s68, v88
    v_lshlrev_b32 v20, 16, v89
    v_and_b32 v21, s68, v89
    v_fma_f32 v14, v14, v12, v13
    v_fma_f32 v15, v15, v12, v13
    s_waitcnt lgkmcnt(8)
    v_mfma_f32_32x32x16_bf16 a[32:47], v[82:85], v[30:33], a[32:47]
    ds_read_b64_tr_b16 v[30:31], v11 offset:4608
    ds_read_b64_tr_b16 v[32:33], v11 offset:4864
    v_fma_f32 v16, v16, v12, v13
    v_fma_f32 v17, v17, v12, v13
    v_fma_f32 v18, v18, v12, v13
    v_fma_f32 v19, v19, v12, v13
    v_fma_f32 v20, v20, v12, v13
    s_waitcnt lgkmcnt(8)
    v_mfma_f32_32x32x16_bf16 a[48:63], v[34:37], v[82:85], a[48:63]
    ds_read_b64_tr_b16 v[34:35], v10 offset:1792
    ds_read_b64_tr_b16 v[36:37], v10 offset:2688
    v_fma_f32 v21, v21, v12, v13
    v_cvt_pk_bf16_f32 v86, v14, v15
    v_cvt_pk_bf16_f32 v87, v16, v17
    v_cvt_pk_bf16_f32 v88, v18, v19
    v_cvt_pk_bf16_f32 v89, v20, v21
    s_waitcnt lgkmcnt(8)
    v_mfma_f32_32x32x16_bf16 a[64:79], v[38:41], v[82:85], a[64:79]
    ds_read_b64_tr_b16 v[38:39], v10 offset:1824
    ds_read_b64_tr_b16 v[40:41], v10 offset:2720
    s_waitcnt vmcnt(13)
    s_barrier
    v_add_u32 v10, 103680, v8
    v_add_u32 v11, 103680, v9
    s_waitcnt lgkmcnt(8)
    v_mfma_f32_32x32x16_bf16 a[0:15], v[22:25], v[86:89], a[0:15]
    ds_read_b64_tr_b16 v[22:23], v11 offset:0
    ds_read_b64_tr_b16 v[24:25], v11 offset:256
    s_add_u32 m0, s36, 62208
    s_nop 0
    buffer_load_dwordx4 v5, s[24:27], s60 offen lds
    s_add_u32 s60, s60, s64
    v_lshlrev_b32 v14, 16, v90
    v_and_b32 v15, s68, v90
    v_lshlrev_b32 v16, 16, v91
    v_and_b32 v17, s68, v91
    v_lshlrev_b32 v18, 16, v92
    s_waitcnt lgkmcnt(8)
    v_mfma_f32_32x32x16_bf16 a[16:31], v[26:29], v[86:89], a[16:31]
    ds_read_b64_tr_b16 v[26:27], v11 offset:2048
    ds_read_b64_tr_b16 v[28:29], v11 offset:2304
    s_add_u32 m0, s37, 62208
    s_nop 0
    buffer_load_dwordx4 v6, s[28:31], s61 offen lds
    s_add_u32 s61, s61, s65
    v_and_b32 v19, s68, v92
    v_lshlrev_b32 v20, 16, v93
    v_and_b32 v21, s68, v93
    v_fma_f32 v14, v14, v12, v13
    v_fma_f32 v15, v15, v12, v13
    s_waitcnt lgkmcnt(8)
    v_mfma_f32_32x32x16_bf16 a[32:47], v[86:89], v[30:33], a[32:47]
    ds_read_b64_tr_b16 v[30:31], v11 offset:4096
    ds_read_b64_tr_b16 v[32:33], v11 offset:4352
    s_add_u32 s57, s38, 62208
    s_cmp_eq_u32 s75, 1
    s_cselect_b32 m0, 153856, s57
    s_nop 0
    buffer_load_dwordx4 v7, s[32:35], s62 offen lds
    s_add_u32 s62, s62, s66
    v_fma_f32 v16, v16, v12, v13
    v_fma_f32 v17, v17, v12, v13
    v_fma_f32 v18, v18, v12, v13
    v_fma_f32 v19, v19, v12, v13
    v_fma_f32 v20, v20, v12, v13
    s_waitcnt lgkmcnt(8)
    v_mfma_f32_32x32x16_bf16 a[48:63], v[34:37], v[86:89], a[48:63]
    ds_read_b64_tr_b16 v[34:35], v10 offset:0
    ds_read_b64_tr_b16 v[36:37], v10 offset:896
    v_fma_f32 v21, v21, v12, v13
    v_cvt_pk_bf16_f32 v90, v14, v15
    v_cvt_pk_bf16_f32 v91, v16, v17
    v_cvt_pk_bf16_f32 v92, v18, v19
    v_cvt_pk_bf16_f32 v93, v20, v21
    s_waitcnt lgkmcnt(8)
    v_mfma_f32_32x32x16_bf16 a[64:79], v[38:41], v[86:89], a[64:79]
    ds_read_b64_tr_b16 v[38:39], v10 offset:32
    ds_read_b64_tr_b16 v[40:41], v10 offset:928
    s_waitcnt lgkmcnt(8)
    v_mfma_f32_32x32x16_bf16 a[0:15], v[22:25], v[90:93], a[0:15]
    ds_read_b64_tr_b16 v[22:23], v11 offset:512
    ds_read_b64_tr_b16 v[24:25], v11 offset:768
    v_lshlrev_b32 v14, 16, v94
    v_and_b32 v15, s68, v94
    v_lshlrev_b32 v16, 16, v95
    v_and_b32 v17, s68, v95
    v_lshlrev_b32 v18, 16, v96
    s_waitcnt lgkmcnt(8)
    v_mfma_f32_32x32x16_bf16 a[16:31], v[26:29], v[90:93], a[16:31]
    ds_read_b64_tr_b16 v[26:27], v11 offset:2560
    ds_read_b64_tr_b16 v[28:29], v11 offset:2816
    v_and_b32 v19, s68, v96
    v_lshlrev_b32 v20, 16, v97
    v_and_b32 v21, s68, v97
    v_fma_f32 v14, v14, v12, v13
    v_fma_f32 v15, v15, v12, v13
    s_waitcnt lgkmcnt(8)
    v_mfma_f32_32x32x16_bf16 a[32:47], v[90:93], v[30:33], a[32:47]
    ds_read_b64_tr_b16 v[30:31], v11 offset:4608
    ds_read_b64_tr_b16 v[32:33], v11 offset:4864
    v_fma_f32 v16, v16, v12, v13
    v_fma_f32 v17, v17, v12, v13
    v_fma_f32 v18, v18, v12, v13
    v_fma_f32 v19, v19, v12, v13
    v_fma_f32 v20, v20, v12, v13
    s_waitcnt lgkmcnt(8)
    v_mfma_f32_32x32x16_bf16 a[48:63], v[34:37], v[90:93], a[48:63]
    ds_read_b64_tr_b16 v[34:35], v10 offset:1792
    ds_read_b64_tr_b16 v[36:37], v10 offset:2688
    v_fma_f32 v21, v21, v12, v13
    v_cvt_pk_bf16_f32 v94, v14, v15
    v_cvt_pk_bf16_f32 v95, v16, v17
    v_cvt_pk_bf16_f32 v96, v18, v19
    v_cvt_pk_bf16_f32 v97, v20, v21
    s_waitcnt lgkmcnt(8)
    v_mfma_f32_32x32x16_bf16 a[64:79], v[38:41], v[90:93], a[64:79]
    ds_read_b64_tr_b16 v[38:39], v10 offset:1824
    ds_read_b64_tr_b16 v[40:41], v10 offset:2720
    s_waitcnt vmcnt(13)
    s_barrier
    v_add_u32 v10, 133120, v8
    v_add_u32 v11, 133120, v9
    s_waitcnt vmcnt(6)
    ds_read_b64_tr_b16 v[172:173], v171
    ds_read_b64_tr_b16 v[174:175], v171 offset:512
    s_waitcnt lgkmcnt(0)
    buffer_store_dwordx4 v[172:175], v2, s[12:15], s72 offen sc1
    s_waitcnt lgkmcnt(8)
    v_mfma_f32_32x32x16_bf16 a[0:15], v[22:25], v[94:97], a[0:15]
    ds_read_b64_tr_b16 v[22:23], v11 offset:0
    ds_read_b64_tr_b16 v[24:25], v11 offset:256
    s_add_u32 m0, s36, 82944
    s_nop 0
    buffer_load_dwordx4 v5, s[24:27], s60 offen lds
    s_add_u32 s60, s60, s64
    v_lshlrev_b32 v14, 16, v98
    v_and_b32 v15, s68, v98
    v_lshlrev_b32 v16, 16, v99
    v_and_b32 v17, s68, v99
    v_lshlrev_b32 v18, 16, v100
    s_waitcnt lgkmcnt(8)
    v_mfma_f32_32x32x16_bf16 a[16:31], v[26:29], v[94:97], a[16:31]
    ds_read_b64_tr_b16 v[26:27], v11 offset:2048
    ds_read_b64_tr_b16 v[28:29], v11 offset:2304
    s_add_u32 m0, s37, 82944
    s_nop 0
    buffer_load_dwordx4 v6, s[28:31], s61 offen lds
    s_add_u32 s61, s61, s65
    v_and_b32 v19, s68, v100
    v_lshlrev_b32 v20, 16, v101
    v_and_b32 v21, s68, v101
    v_fma_f32 v14, v14, v12, v13
    v_fma_f32 v15, v15, v12, v13
    s_waitcnt lgkmcnt(8)
    v_mfma_f32_32x32x16_bf16 a[32:47], v[94:97], v[30:33], a[32:47]
    ds_read_b64_tr_b16 v[30:31], v11 offset:4096
    ds_read_b64_tr_b16 v[32:33], v11 offset:4352
    s_add_u32 s57, s38, 82944
    s_cmp_eq_u32 s75, 1
    s_cselect_b32 m0, 153856, s57
    s_nop 0
    buffer_load_dwordx4 v7, s[32:35], s62 offen lds
    s_add_u32 s62, s62, s66
    v_fma_f32 v16, v16, v12, v13
    v_fma_f32 v17, v17, v12, v13
    v_fma_f32 v18, v18, v12, v13
    v_fma_f32 v19, v19, v12, v13
    v_fma_f32 v20, v20, v12, v13
    s_waitcnt lgkmcnt(8)
    v_mfma_f32_32x32x16_bf16 a[48:63], v[34:37], v[94:97], a[48:63]
    ds_read_b64_tr_b16 v[34:35], v10 offset:0
    ds_read_b64_tr_b16 v[36:37], v10 offset:896
    v_fma_f32 v21, v21, v12, v13
    v_cvt_pk_bf16_f32 v98, v14, v15
    v_cvt_pk_bf16_f32 v99, v16, v17
    v_cvt_pk_bf16_f32 v100, v18, v19
    v_cvt_pk_bf16_f32 v101, v20, v21
    s_waitcnt lgkmcnt(8)
    v_mfma_f32_32x32x16_bf16 a[64:79], v[38:41], v[94:97], a[64:79]
    ds_read_b64_tr_b16 v[38:39], v10 offset:32
    ds_read_b64_tr_b16 v[40:41], v10 offset:928
    s_waitcnt lgkmcnt(8)
    v_mfma_f32_32x32x16_bf16 a[0:15], v[22:25], v[98:101], a[0:15]
    ds_read_b64_tr_b16 v[22:23], v11 offset:512
    ds_read_b64_tr_b16 v[24:25], v11 offset:768
    v_lshlrev_b32 v14, 16, v102
    v_and_b32 v15, s68, v102
    v_lshlrev_b32 v16, 16, v103
    v_and_b32 v17, s68, v103
    v_lshlrev_b32 v18, 16, v104
    s_waitcnt lgkmcnt(8)
    v_mfma_f32_32x32x16_bf16 a[16:31], v[26:29], v[98:101], a[16:31]
    ds_read_b64_tr_b16 v[26:27], v11 offset:2560
    ds_read_b64_tr_b16 v[28:29], v11 offset:2816
    v_and_b32 v19, s68, v104
    v_lshlrev_b32 v20, 16, v105
    v_and_b32 v21, s68, v105
    v_fma_f32 v14, v14, v12, v13
    v_fma_f32 v15, v15, v12, v13
    s_waitcnt lgkmcnt(8)
    v_mfma_f32_32x32x16_bf16 a[32:47], v[98:101], v[30:33], a[32:47]
    ds_read_b64_tr_b16 v[30:31], v11 offset:4608
    ds_read_b64_tr_b16 v[32:33], v11 offset:4864
    v_fma_f32 v16, v16, v12, v13
    v_fma_f32 v17, v17, v12, v13
    v_fma_f32 v18, v18, v12, v13
    v_fma_f32 v19, v19, v12, v13
    v_fma_f32 v20, v20, v12, v13
    s_waitcnt lgkmcnt(8)
    v_mfma_f32_32x32x16_bf16 a[48:63], v[34:37], v[98:101], a[48:63]
    ds_read_b64_tr_b16 v[34:35], v10 offset:1792
    ds_read_b64_tr_b16 v[36:37], v10 offset:2688
    v_fma_f32 v21, v21, v12, v13
    v_cvt_pk_bf16_f32 v102, v14, v15
    v_cvt_pk_bf16_f32 v103, v16, v17
    v_cvt_pk_bf16_f32 v104, v18, v19
    v_cvt_pk_bf16_f32 v105, v20, v21
    s_waitcnt lgkmcnt(8)
    v_mfma_f32_32x32x16_bf16 a[64:79], v[38:41], v[98:101], a[64:79]
    ds_read_b64_tr_b16 v[38:39], v10 offset:1824
    ds_read_b64_tr_b16 v[40:41], v10 offset:2720
    s_waitcnt vmcnt(14)
    s_barrier
    v_add_u32 v10, 0, v8
    v_add_u32 v11, 0, v9
    s_waitcnt lgkmcnt(8)
    v_mfma_f32_32x32x16_bf16 a[0:15], v[22:25], v[102:105], a[0:15]
    ds_read_b64_tr_b16 v[22:23], v11 offset:0
    ds_read_b64_tr_b16 v[24:25], v11 offset:256
    s_add_u32 m0, s36, 103680
    s_nop 0
    buffer_load_dwordx4 v5, s[24:27], s60 offen lds
    s_add_u32 s60, s60, s64
    v_lshlrev_b32 v14, 16, v106
    v_and_b32 v15, s68, v106
    v_lshlrev_b32 v16, 16, v107
    v_and_b32 v17, s68, v107
    v_lshlrev_b32 v18, 16, v108
    s_waitcnt lgkmcnt(8)
    v_mfma_f32_32x32x16_bf16 a[16:31], v[26:29], v[102:105], a[16:31]
    ds_read_b64_tr_b16 v[26:27], v11 offset:2048
    ds_read_b64_tr_b16 v[28:29], v11 offset:2304
    s_add_u32 m0, s37, 103680
    s_nop 0
    buffer_load_dwordx4 v6, s[28:31], s61 offen lds
    s_add_u32 s61, s61, s65
    v_and_b32 v19, s68, v108
    v_lshlrev_b32 v20, 16, v109
    v_and_b32 v21, s68, v109
    v_fma_f32 v14, v14, v12, v13
    v_fma_f32 v15, v15, v12, v13
    s_waitcnt lgkmcnt(8)
    v_mfma_f32_32x32x16_bf16 a[32:47], v[102:105], v[30:33], a[32:47]
    ds_read_b64_tr_b16 v[30:31], v11 offset:4096
    ds_read_b64_tr_b16 v[32:33], v11 offset:4352
    s_add_u32 s57, s38, 103680
    s_cmp_eq_u32 s75, 1
    s_cselect_b32 m0, 153856, s57
    s_nop 0
    buffer_load_dwordx4 v7, s[32:35], s62 offen lds
    s_add_u32 s62, s62, s66
    v_fma_f32 v16, v16, v12, v13
    v_fma_f32 v17, v17, v12, v13
    v_fma_f32 v18, v18, v12, v13
    v_fma_f32 v19, v19, v12, v13
    v_fma_f32 v20, v20, v12, v13
    s_waitcnt lgkmcnt(8)
    v_mfma_f32_32x32x16_bf16 a[48:63], v[34:37], v[102:105], a[48:63]
    ds_read_b64_tr_b16 v[34:35], v10 offset:0
    ds_read_b64_tr_b16 v[36:37], v10 offset:896
    v_fma_f32 v21, v21, v12, v13
    v_cvt_pk_bf16_f32 v106, v14, v15
    v_cvt_pk_bf16_f32 v107, v16, v17
    v_cvt_pk_bf16_f32 v108, v18, v19
    v_cvt_pk_bf16_f32 v109, v20, v21
    s_waitcnt lgkmcnt(8)
    v_mfma_f32_32x32x16_bf16 a[64:79], v[38:41], v[102:105], a[64:79]
    ds_read_b64_tr_b16 v[38:39], v10 offset:32
    ds_read_b64_tr_b16 v[40:41], v10 offset:928
    s_add_u32 s55, s73, 2048
    s_lshr_b32 s56, s55, 4
    s_and_b32 s55, s55, 15
    s_mul_i32 s72, s55, 144
    s_add_u32 s72, s72, s56
    s_lshl_b32 s72, s72, 10
    s_add_u32 s72, s72, 10485760
    s_mov_b32 s18, 524288
    s_cmp_lt_u32 s56, 112
    s_cselect_b32 s16, s50, s48
    s_cselect_b32 s17, s51, s49
    s_cselect_b32 s18, 1835008, s18
    s_cselect_b32 s54, 0, 112
    s_and_b32 s17, s17, 0xffff
    s_mov_b32 s19, 0x00020000
    s_sub_u32 s56, s56, s54
    s_lshl_b32 s56, s56, 14
    s_mov_b32 m0, s74
    s_lshl_b32 s55, s55, 6
    s_add_u32 s56, s56, s55
    buffer_load_dwordx4 v170, s[16:19], s56 offen lds
    s_waitcnt lgkmcnt(8)
    v_mfma_f32_32x32x16_bf16 a[0:15], v[22:25], v[106:109], a[0:15]
    ds_read_b64_tr_b16 v[22:23], v11 offset:512
    ds_read_b64_tr_b16 v[24:25], v11 offset:768
    v_lshlrev_b32 v14, 16, v110
    v_and_b32 v15, s68, v110
    v_lshlrev_b32 v16, 16, v111
    v_and_b32 v17, s68, v111
    v_lshlrev_b32 v18, 16, v112
    s_waitcnt lgkmcnt(8)
    v_mfma_f32_32x32x16_bf16 a[16:31], v[26:29], v[106:109], a[16:31]
    ds_read_b64_tr_b16 v[26:27], v11 offset:2560
    ds_read_b64_tr_b16 v[28:29], v11 offset:2816
    v_and_b32 v19, s68, v112
    v_lshlrev_b32 v20, 16, v113
    v_and_b32 v21, s68, v113
    v_fma_f32 v14, v14, v12, v13
    v_fma_f32 v15, v15, v12, v13
    s_waitcnt lgkmcnt(8)
    v_mfma_f32_32x32x16_bf16 a[32:47], v[106:109], v[30:33], a[32:47]
    ds_read_b64_tr_b16 v[30:31], v11 offset:4608
    ds_read_b64_tr_b16 v[32:33], v11 offset:4864
    v_fma_f32 v16, v16, v12, v13
    v_fma_f32 v17, v17, v12, v13
    v_fma_f32 v18, v18, v12, v13
    v_fma_f32 v19, v19, v12, v13
    v_fma_f32 v20, v20, v12, v13
    s_waitcnt lgkmcnt(8)
    v_mfma_f32_32x32x16_bf16 a[48:63], v[34:37], v[106:109], a[48:63]
    ds_read_b64_tr_b16 v[34:35], v10 offset:1792
    ds_read_b64_tr_b16 v[36:37], v10 offset:2688
    v_fma_f32 v21, v21, v12, v13
    v_cvt_pk_bf16_f32 v110, v14, v15
    v_cvt_pk_bf16_f32 v111, v16, v17
    v_cvt_pk_bf16_f32 v112, v18, v19
    v_cvt_pk_bf16_f32 v113, v20, v21
    s_waitcnt lgkmcnt(8)
    v_mfma_f32_32x32x16_bf16 a[64:79], v[38:41], v[106:109], a[64:79]
    ds_read_b64_tr_b16 v[38:39], v10 offset:1824
    ds_read_b64_tr_b16 v[40:41], v10 offset:2720
    s_waitcnt vmcnt(15)
    s_barrier
    v_add_u32 v10, 20736, v8
    v_add_u32 v11, 20736, v9
    s_waitcnt lgkmcnt(8)
    v_mfma_f32_32x32x16_bf16 a[0:15], v[22:25], v[110:113], a[0:15]
    ds_read_b64_tr_b16 v[22:23], v11 offset:0
    ds_read_b64_tr_b16 v[24:25], v11 offset:256
    s_add_u32 m0, s36, 133120
    s_nop 0
    buffer_load_dwordx4 v5, s[24:27], s60 offen lds
    s_add_u32 s60, s60, s64
    v_lshlrev_b32 v14, 16, v114
    v_and_b32 v15, s68, v114
    v_lshlrev_b32 v16, 16, v115
    v_and_b32 v17, s68, v115
    v_lshlrev_b32 v18, 16, v116
    s_waitcnt lgkmcnt(8)
    v_mfma_f32_32x32x16_bf16 a[16:31], v[26:29], v[110:113], a[16:31]
    ds_read_b64_tr_b16 v[26:27], v11 offset:2048
    ds_read_b64_tr_b16 v[28:29], v11 offset:2304
    s_add_u32 m0, s37, 133120
    s_nop 0
    buffer_load_dwordx4 v6, s[28:31], s61 offen lds
    s_add_u32 s61, s61, s65
    v_and_b32 v19, s68, v116
    v_lshlrev_b32 v20, 16, v117
    v_and_b32 v21, s68, v117
    v_fma_f32 v14, v14, v12, v13
    v_fma_f32 v15, v15, v12, v13
    s_waitcnt lgkmcnt(8)
    v_mfma_f32_32x32x16_bf16 a[32:47], v[110:113], v[30:33], a[32:47]
    ds_read_b64_tr_b16 v[30:31], v11 offset:4096
    ds_read_b64_tr_b16 v[32:33], v11 offset:4352
    s_add_u32 s57, s38, 133120
    s_cmp_eq_u32 s75, 1
    s_cselect_b32 m0, 153856, s57
    s_nop 0
    buffer_load_dwordx4 v7, s[32:35], s62 offen lds
    s_add_u32 s62, s62, s66
    v_fma_f32 v16, v16, v12, v13
    v_fma_f32 v17, v17, v12, v13
    v_fma_f32 v18, v18, v12, v13
    v_fma_f32 v19, v19, v12, v13
    v_fma_f32 v20, v20, v12, v13
    s_waitcnt lgkmcnt(8)
    v_mfma_f32_32x32x16_bf16 a[48:63], v[34:37], v[110:113], a[48:63]
    ds_read_b64_tr_b16 v[34:35], v10 offset:0
    ds_read_b64_tr_b16 v[36:37], v10 offset:896
    v_fma_f32 v21, v21, v12, v13
    v_cvt_pk_bf16_f32 v114, v14, v15
    v_cvt_pk_bf16_f32 v115, v16, v17
    v_cvt_pk_bf16_f32 v116, v18, v19
    v_cvt_pk_bf16_f32 v117, v20, v21
    s_waitcnt lgkmcnt(8)
    v_mfma_f32_32x32x16_bf16 a[64:79], v[38:41], v[110:113], a[64:79]
    ds_read_b64_tr_b16 v[38:39], v10 offset:32
    ds_read_b64_tr_b16 v[40:41], v10 offset:928
    s_waitcnt lgkmcnt(8)
    v_mfma_f32_32x32x16_bf16 a[0:15], v[22:25], v[114:117], a[0:15]
    ds_read_b64_tr_b16 v[22:23], v11 offset:512
    ds_read_b64_tr_b16 v[24:25], v11 offset:768
    v_lshlrev_b32 v14, 16, v118
    v_and_b32 v15, s68, v118
    v_lshlrev_b32 v16, 16, v119
    v_and_b32 v17, s68, v119
    v_lshlrev_b32 v18, 16, v120
    s_waitcnt lgkmcnt(8)
    v_mfma_f32_32x32x16_bf16 a[16:31], v[26:29], v[114:117], a[16:31]
    ds_read_b64_tr_b16 v[26:27], v11 offset:2560
    ds_read_b64_tr_b16 v[28:29], v11 offset:2816
    v_and_b32 v19, s68, v120
    v_lshlrev_b32 v20, 16, v121
    v_and_b32 v21, s68, v121
    v_fma_f32 v14, v14, v12, v13
    v_fma_f32 v15, v15, v12, v13
    s_waitcnt lgkmcnt(8)
    v_mfma_f32_32x32x16_bf16 a[32:47], v[114:117], v[30:33], a[32:47]
    ds_read_b64_tr_b16 v[30:31], v11 offset:4608
    ds_read_b64_tr_b16 v[32:33], v11 offset:4864
    v_fma_f32 v16, v16, v12, v13
    v_fma_f32 v17, v17, v12, v13
    v_fma_f32 v18, v18, v12, v13
    v_fma_f32 v19, v19, v12, v13
    v_fma_f32 v20, v20, v12, v13
    s_waitcnt lgkmcnt(8)
    v_mfma_f32_32x32x16_bf16 a[48:63], v[34:37], v[114:117], a[48:63]
    ds_read_b64_tr_b16 v[34:35], v10 offset:1792
    ds_read_b64_tr_b16 v[36:37], v10 offset:2688
    v_fma_f32 v21, v21, v12, v13
    v_cvt_pk_bf16_f32 v118, v14, v15
    v_cvt_pk_bf16_f32 v119, v16, v17
    v_cvt_pk_bf16_f32 v120, v18, v19
    v_cvt_pk_bf16_f32 v121, v20, v21
    s_waitcnt lgkmcnt(8)
    v_mfma_f32_32x32x16_bf16 a[64:79], v[38:41], v[114:117], a[64:79]
    ds_read_b64_tr_b16 v[38:39], v10 offset:1824
    ds_read_b64_tr_b16 v[40:41], v10 offset:2720
    s_waitcnt vmcnt(14)
    s_barrier
    v_add_u32 v10, 41472, v8
    v_add_u32 v11, 41472, v9
    s_waitcnt lgkmcnt(8)
    v_mfma_f32_32x32x16_bf16 a[0:15], v[22:25], v[118:121], a[0:15]
    ds_read_b64_tr_b16 v[22:23], v11 offset:0
    ds_read_b64_tr_b16 v[24:25], v11 offset:256
    s_add_u32 m0, s36, 0
    s_nop 0
    buffer_load_dwordx4 v5, s[24:27], s60 offen lds
    s_add_u32 s60, s60, s64
    v_lshlrev_b32 v14, 16, v122
    v_and_b32 v15, s68, v122
    v_lshlrev_b32 v16, 16, v123
    v_and_b32 v17, s68, v123
    v_lshlrev_b32 v18, 16, v124
    s_waitcnt lgkmcnt(8)
    v_mfma_f32_32x32x16_bf16 a[16:31], v[26:29], v[118:121], a[16:31]
    ds_read_b64_tr_b16 v[26:27], v11 offset:2048
    ds_read_b64_tr_b16 v[28:29], v11 offset:2304
    s_add_u32 m0, s37, 0
    s_nop 0
    buffer_load_dwordx4 v6, s[28:31], s61 offen lds
    s_add_u32 s61, s61, s65
    v_and_b32 v19, s68, v124
    v_lshlrev_b32 v20, 16, v125
    v_and_b32 v21, s68, v125
    v_fma_f32 v14, v14, v12, v13
    v_fma_f32 v15, v15, v12, v13
    s_waitcnt lgkmcnt(8)
    v_mfma_f32_32x32x16_bf16 a[32:47], v[118:121], v[30:33], a[32:47]
    ds_read_b64_tr_b16 v[30:31], v11 offset:4096
    ds_read_b64_tr_b16 v[32:33], v11 offset:4352
    s_add_u32 s57, s38, 0
    s_cmp_eq_u32 s75, 1
    s_cselect_b32 m0, 153856, s57
    s_nop 0
    buffer_load_dwordx4 v7, s[32:35], s62 offen lds
    s_add_u32 s62, s62, s66
    v_fma_f32 v16, v16, v12, v13
    v_fma_f32 v17, v17, v12, v13
    v_fma_f32 v18, v18, v12, v13
    v_fma_f32 v19, v19, v12, v13
    v_fma_f32 v20, v20, v12, v13
    s_waitcnt lgkmcnt(8)
    v_mfma_f32_32x32x16_bf16 a[48:63], v[34:37], v[118:121], a[48:63]
    ds_read_b64_tr_b16 v[34:35], v10 offset:0
    ds_read_b64_tr_b16 v[36:37], v10 offset:896
    v_fma_f32 v21, v21, v12, v13
    v_cvt_pk_bf16_f32 v122, v14, v15
    v_cvt_pk_bf16_f32 v123, v16, v17
    v_cvt_pk_bf16_f32 v124, v18, v19
    v_cvt_pk_bf16_f32 v125, v20, v21
    s_waitcnt lgkmcnt(8)
    v_mfma_f32_32x32x16_bf16 a[64:79], v[38:41], v[118:121], a[64:79]
    ds_read_b64_tr_b16 v[38:39], v10 offset:32
    ds_read_b64_tr_b16 v[40:41], v10 offset:928
    s_waitcnt lgkmcnt(8)
    v_mfma_f32_32x32x16_bf16 a[0:15], v[22:25], v[122:125], a[0:15]
    ds_read_b64_tr_b16 v[22:23], v11 offset:512
    ds_read_b64_tr_b16 v[24:25], v11 offset:768
    v_lshlrev_b32 v14, 16, v126
    v_and_b32 v15, s68, v126
    v_lshlrev_b32 v16, 16, v127
    v_and_b32 v17, s68, v127
    v_lshlrev_b32 v18, 16, v128
    s_waitcnt lgkmcnt(8)
    v_mfma_f32_32x32x16_bf16 a[16:31], v[26:29], v[122:125], a[16:31]
    ds_read_b64_tr_b16 v[26:27], v11 offset:2560
    ds_read_b64_tr_b16 v[28:29], v11 offset:2816
    v_and_b32 v19, s68, v128
    v_lshlrev_b32 v20, 16, v129
    v_and_b32 v21, s68, v129
    v_fma_f32 v14, v14, v12, v13
    v_fma_f32 v15, v15, v12, v13
    s_waitcnt lgkmcnt(8)
    v_mfma_f32_32x32x16_bf16 a[32:47], v[122:125], v[30:33], a[32:47]
    ds_read_b64_tr_b16 v[30:31], v11 offset:4608
    ds_read_b64_tr_b16 v[32:33], v11 offset:4864
    v_fma_f32 v16, v16, v12, v13
    v_fma_f32 v17, v17, v12, v13
    v_fma_f32 v18, v18, v12, v13
    v_fma_f32 v19, v19, v12, v13
    v_fma_f32 v20, v20, v12, v13
    s_waitcnt lgkmcnt(8)
    v_mfma_f32_32x32x16_bf16 a[48:63], v[34:37], v[122:125], a[48:63]
    ds_read_b64_tr_b16 v[34:35], v10 offset:1792
    ds_read_b64_tr_b16 v[36:37], v10 offset:2688
    v_fma_f32 v21, v21, v12, v13
    v_cvt_pk_bf16_f32 v126, v14, v15
    v_cvt_pk_bf16_f32 v127, v16, v17
    v_cvt_pk_bf16_f32 v128, v18, v19
    v_cvt_pk_bf16_f32 v129, v20, v21
    s_waitcnt lgkmcnt(8)
    v_mfma_f32_32x32x16_bf16 a[64:79], v[38:41], v[122:125], a[64:79]
    ds_read_b64_tr_b16 v[38:39], v10 offset:1824
    ds_read_b64_tr_b16 v[40:41], v10 offset:2720
    s_waitcnt vmcnt(14)
    s_barrier
    v_add_u32 v10, 62208, v8
    v_add_u32 v11, 62208, v9
    s_waitcnt vmcnt(6)
    ds_read_b64_tr_b16 v[172:173], v171
    ds_read_b64_tr_b16 v[174:175], v171 offset:512
    s_waitcnt lgkmcnt(0)
    buffer_store_dwordx4 v[172:175], v2, s[20:23], s72 offen sc1
    s_waitcnt lgkmcnt(8)
    v_mfma_f32_32x32x16_bf16 a[0:15], v[22:25], v[126:129], a[0:15]
    ds_read_b64_tr_b16 v[22:23], v11 offset:0
    ds_read_b64_tr_b16 v[24:25], v11 offset:256
    v_lshlrev_b32 v14, 16, v130
    v_and_b32 v15, s68, v130
    v_lshlrev_b32 v16, 16, v131
    v_and_b32 v17, s68, v131
    v_lshlrev_b32 v18, 16, v132
    s_waitcnt lgkmcnt(8)
    v_mfma_f32_32x32x16_bf16 a[16:31], v[26:29], v[126:129], a[16:31]
    ds_read_b64_tr_b16 v[26:27], v11 offset:2048
    ds_read_b64_tr_b16 v[28:29], v11 offset:2304
    v_and_b32 v19, s68, v132
    v_lshlrev_b32 v20, 16, v133
    v_and_b32 v21, s68, v133
    v_fma_f32 v14, v14, v12, v13
    v_fma_f32 v15, v15, v12, v13
    s_waitcnt lgkmcnt(8)
    v_mfma_f32_32x32x16_bf16 a[32:47], v[126:129], v[30:33], a[32:47]
    ds_read_b64_tr_b16 v[30:31], v11 offset:4096
    ds_read_b64_tr_b16 v[32:33], v11 offset:4352
    v_fma_f32 v16, v16, v12, v13
    v_fma_f32 v17, v17, v12, v13
    v_fma_f32 v18, v18, v12, v13
    v_fma_f32 v19, v19, v12, v13
    v_fma_f32 v20, v20, v12, v13
    s_waitcnt lgkmcnt(8)
    v_mfma_f32_32x32x16_bf16 a[48:63], v[34:37], v[126:129], a[48:63]
    ds_read_b64_tr_b16 v[34:35], v10 offset:0
    ds_read_b64_tr_b16 v[36:37], v10 offset:896
    v_fma_f32 v21, v21, v12, v13
    v_cvt_pk_bf16_f32 v130, v14, v15
    v_cvt_pk_bf16_f32 v131, v16, v17
    v_cvt_pk_bf16_f32 v132, v18, v19
    v_cvt_pk_bf16_f32 v133, v20, v21
    s_waitcnt lgkmcnt(8)
    v_mfma_f32_32x32x16_bf16 a[64:79], v[38:41], v[126:129], a[64:79]
    ds_read_b64_tr_b16 v[38:39], v10 offset:32
    ds_read_b64_tr_b16 v[40:41], v10 offset:928
    s_waitcnt lgkmcnt(8)
    v_mfma_f32_32x32x16_bf16 a[0:15], v[22:25], v[130:133], a[0:15]
    ds_read_b64_tr_b16 v[22:23], v11 offset:512
    ds_read_b64_tr_b16 v[24:25], v11 offset:768
    v_lshlrev_b32 v14, 16, v134
    v_and_b32 v15, s68, v134
    v_lshlrev_b32 v16, 16, v135
    v_and_b32 v17, s68, v135
    v_lshlrev_b32 v18, 16, v136
    s_waitcnt lgkmcnt(8)
    v_mfma_f32_32x32x16_bf16 a[16:31], v[26:29], v[130:133], a[16:31]
    ds_read_b64_tr_b16 v[26:27], v11 offset:2560
    ds_read_b64_tr_b16 v[28:29], v11 offset:2816
    v_and_b32 v19, s68, v136
    v_lshlrev_b32 v20, 16, v137
    v_and_b32 v21, s68, v137
    v_fma_f32 v14, v14, v12, v13
    v_fma_f32 v15, v15, v12, v13
    s_waitcnt lgkmcnt(8)
    v_mfma_f32_32x32x16_bf16 a[32:47], v[130:133], v[30:33], a[32:47]
    ds_read_b64_tr_b16 v[30:31], v11 offset:4608
    ds_read_b64_tr_b16 v[32:33], v11 offset:4864
    v_fma_f32 v16, v16, v12, v13
    v_fma_f32 v17, v17, v12, v13
    v_fma_f32 v18, v18, v12, v13
    v_fma_f32 v19, v19, v12, v13
    v_fma_f32 v20, v20, v12, v13
    s_waitcnt lgkmcnt(8)
    v_mfma_f32_32x32x16_bf16 a[48:63], v[34:37], v[130:133], a[48:63]
    ds_read_b64_tr_b16 v[34:35], v10 offset:1792
    ds_read_b64_tr_b16 v[36:37], v10 offset:2688
    v_fma_f32 v21, v21, v12, v13
    v_cvt_pk_bf16_f32 v134, v14, v15
    v_cvt_pk_bf16_f32 v135, v16, v17
    v_cvt_pk_bf16_f32 v136, v18, v19
    v_cvt_pk_bf16_f32 v137, v20, v21
    s_waitcnt lgkmcnt(8)
    v_mfma_f32_32x32x16_bf16 a[64:79], v[38:41], v[130:133], a[64:79]
    ds_read_b64_tr_b16 v[38:39], v10 offset:1824
    ds_read_b64_tr_b16 v[40:41], v10 offset:2720
    s_waitcnt vmcnt(11)
    s_barrier
    v_add_u32 v10, 82944, v8
    v_add_u32 v11, 82944, v9
    s_waitcnt lgkmcnt(8)
    v_mfma_f32_32x32x16_bf16 a[0:15], v[22:25], v[134:137], a[0:15]
    ds_read_b64_tr_b16 v[22:23], v11 offset:0
    ds_read_b64_tr_b16 v[24:25], v11 offset:256
    v_lshlrev_b32 v14, 16, v138
    v_and_b32 v15, s68, v138
    v_lshlrev_b32 v16, 16, v139
    v_and_b32 v17, s68, v139
    v_lshlrev_b32 v18, 16, v140
    s_waitcnt lgkmcnt(8)
    v_mfma_f32_32x32x16_bf16 a[16:31], v[26:29], v[134:137], a[16:31]
    ds_read_b64_tr_b16 v[26:27], v11 offset:2048
    ds_read_b64_tr_b16 v[28:29], v11 offset:2304
    v_and_b32 v19, s68, v140
    v_lshlrev_b32 v20, 16, v141
    v_and_b32 v21, s68, v141
    v_fma_f32 v14, v14, v12, v13
    v_fma_f32 v15, v15, v12, v13
    s_waitcnt lgkmcnt(8)
    v_mfma_f32_32x32x16_bf16 a[32:47], v[134:137], v[30:33], a[32:47]
    ds_read_b64_tr_b16 v[30:31], v11 offset:4096
    ds_read_b64_tr_b16 v[32:33], v11 offset:4352
    v_fma_f32 v16, v16, v12, v13
    v_fma_f32 v17, v17, v12, v13
    v_fma_f32 v18, v18, v12, v13
    v_fma_f32 v19, v19, v12, v13
    v_fma_f32 v20, v20, v12, v13
    s_waitcnt lgkmcnt(8)
    v_mfma_f32_32x32x16_bf16 a[48:63], v[34:37], v[134:137], a[48:63]
    ds_read_b64_tr_b16 v[34:35], v10 offset:0
    ds_read_b64_tr_b16 v[36:37], v10 offset:896
    v_fma_f32 v21, v21, v12, v13
    v_cvt_pk_bf16_f32 v138, v14, v15
    v_cvt_pk_bf16_f32 v139, v16, v17
    v_cvt_pk_bf16_f32 v140, v18, v19
    v_cvt_pk_bf16_f32 v141, v20, v21
    s_waitcnt lgkmcnt(8)
    v_mfma_f32_32x32x16_bf16 a[64:79], v[38:41], v[134:137], a[64:79]
    ds_read_b64_tr_b16 v[38:39], v10 offset:32
    ds_read_b64_tr_b16 v[40:41], v10 offset:928
    s_waitcnt lgkmcnt(8)
    v_mfma_f32_32x32x16_bf16 a[0:15], v[22:25], v[138:141], a[0:15]
    ds_read_b64_tr_b16 v[22:23], v11 offset:512
    ds_read_b64_tr_b16 v[24:25], v11 offset:768
    v_lshlrev_b32 v14, 16, v142
    v_and_b32 v15, s68, v142
    v_lshlrev_b32 v16, 16, v143
    v_and_b32 v17, s68, v143
    v_lshlrev_b32 v18, 16, v144
    s_waitcnt lgkmcnt(8)
    v_mfma_f32_32x32x16_bf16 a[16:31], v[26:29], v[138:141], a[16:31]
    ds_read_b64_tr_b16 v[26:27], v11 offset:2560
    ds_read_b64_tr_b16 v[28:29], v11 offset:2816
    v_and_b32 v19, s68, v144
    v_lshlrev_b32 v20, 16, v145
    v_and_b32 v21, s68, v145
    v_fma_f32 v14, v14, v12, v13
    v_fma_f32 v15, v15, v12, v13
    s_waitcnt lgkmcnt(8)
    v_mfma_f32_32x32x16_bf16 a[32:47], v[138:141], v[30:33], a[32:47]
    ds_read_b64_tr_b16 v[30:31], v11 offset:4608
    ds_read_b64_tr_b16 v[32:33], v11 offset:4864
    v_fma_f32 v16, v16, v12, v13
    v_fma_f32 v17, v17, v12, v13
    v_fma_f32 v18, v18, v12, v13
    v_fma_f32 v19, v19, v12, v13
    v_fma_f32 v20, v20, v12, v13
    s_waitcnt lgkmcnt(8)
    v_mfma_f32_32x32x16_bf16 a[48:63], v[34:37], v[138:141], a[48:63]
    ds_read_b64_tr_b16 v[34:35], v10 offset:1792
    ds_read_b64_tr_b16 v[36:37], v10 offset:2688
    v_fma_f32 v21, v21, v12, v13
    v_cvt_pk_bf16_f32 v142, v14, v15
    v_cvt_pk_bf16_f32 v143, v16, v17
    v_cvt_pk_bf16_f32 v144, v18, v19
    v_cvt_pk_bf16_f32 v145, v20, v21
    s_waitcnt lgkmcnt(8)
    v_mfma_f32_32x32x16_bf16 a[64:79], v[38:41], v[138:141], a[64:79]
    ds_read_b64_tr_b16 v[38:39], v10 offset:1824
    ds_read_b64_tr_b16 v[40:41], v10 offset:2720
    s_waitcnt vmcnt(8)
    s_barrier
    v_add_u32 v10, 103680, v8
    v_add_u32 v11, 103680, v9
    s_waitcnt lgkmcnt(8)
    v_mfma_f32_32x32x16_bf16 a[0:15], v[22:25], v[142:145], a[0:15]
    ds_read_b64_tr_b16 v[22:23], v11 offset:0
    ds_read_b64_tr_b16 v[24:25], v11 offset:256
    v_lshlrev_b32 v14, 16, v146
    v_and_b32 v15, s68, v146
    v_lshlrev_b32 v16, 16, v147
    v_and_b32 v17, s68, v147
    v_lshlrev_b32 v18, 16, v148
    s_waitcnt lgkmcnt(8)
    v_mfma_f32_32x32x16_bf16 a[16:31], v[26:29], v[142:145], a[16:31]
    ds_read_b64_tr_b16 v[26:27], v11 offset:2048
    ds_read_b64_tr_b16 v[28:29], v11 offset:2304
    v_and_b32 v19, s68, v148
    v_lshlrev_b32 v20, 16, v149
    v_and_b32 v21, s68, v149
    v_fma_f32 v14, v14, v12, v13
    v_fma_f32 v15, v15, v12, v13
    s_waitcnt lgkmcnt(8)
    v_mfma_f32_32x32x16_bf16 a[32:47], v[142:145], v[30:33], a[32:47]
    ds_read_b64_tr_b16 v[30:31], v11 offset:4096
    ds_read_b64_tr_b16 v[32:33], v11 offset:4352
    v_fma_f32 v16, v16, v12, v13
    v_fma_f32 v17, v17, v12, v13
    v_fma_f32 v18, v18, v12, v13
    v_fma_f32 v19, v19, v12, v13
    v_fma_f32 v20, v20, v12, v13
    s_waitcnt lgkmcnt(8)
    v_mfma_f32_32x32x16_bf16 a[48:63], v[34:37], v[142:145], a[48:63]
    ds_read_b64_tr_b16 v[34:35], v10 offset:0
    ds_read_b64_tr_b16 v[36:37], v10 offset:896
    v_fma_f32 v21, v21, v12, v13
    v_cvt_pk_bf16_f32 v146, v14, v15
    v_cvt_pk_bf16_f32 v147, v16, v17
    v_cvt_pk_bf16_f32 v148, v18, v19
    v_cvt_pk_bf16_f32 v149, v20, v21
    s_waitcnt lgkmcnt(8)
    v_mfma_f32_32x32x16_bf16 a[64:79], v[38:41], v[142:145], a[64:79]
    ds_read_b64_tr_b16 v[38:39], v10 offset:32
    ds_read_b64_tr_b16 v[40:41], v10 offset:928
    s_waitcnt lgkmcnt(8)
    v_mfma_f32_32x32x16_bf16 a[0:15], v[22:25], v[146:149], a[0:15]
    ds_read_b64_tr_b16 v[22:23], v11 offset:512
    ds_read_b64_tr_b16 v[24:25], v11 offset:768
    v_lshlrev_b32 v14, 16, v150
    v_and_b32 v15, s68, v150
    v_lshlrev_b32 v16, 16, v151
    v_and_b32 v17, s68, v151
    v_lshlrev_b32 v18, 16, v152
    s_waitcnt lgkmcnt(8)
    v_mfma_f32_32x32x16_bf16 a[16:31], v[26:29], v[146:149], a[16:31]
    ds_read_b64_tr_b16 v[26:27], v11 offset:2560
    ds_read_b64_tr_b16 v[28:29], v11 offset:2816
    v_and_b32 v19, s68, v152
    v_lshlrev_b32 v20, 16, v153
    v_and_b32 v21, s68, v153
    v_fma_f32 v14, v14, v12, v13
    v_fma_f32 v15, v15, v12, v13
    s_waitcnt lgkmcnt(8)
    v_mfma_f32_32x32x16_bf16 a[32:47], v[146:149], v[30:33], a[32:47]
    ds_read_b64_tr_b16 v[30:31], v11 offset:4608
    ds_read_b64_tr_b16 v[32:33], v11 offset:4864
    v_fma_f32 v16, v16, v12, v13
    v_fma_f32 v17, v17, v12, v13
    v_fma_f32 v18, v18, v12, v13
    v_fma_f32 v19, v19, v12, v13
    v_fma_f32 v20, v20, v12, v13
    s_waitcnt lgkmcnt(8)
    v_mfma_f32_32x32x16_bf16 a[48:63], v[34:37], v[146:149], a[48:63]
    ds_read_b64_tr_b16 v[34:35], v10 offset:1792
    ds_read_b64_tr_b16 v[36:37], v10 offset:2688
    v_fma_f32 v21, v21, v12, v13
    v_cvt_pk_bf16_f32 v150, v14, v15
    v_cvt_pk_bf16_f32 v151, v16, v17
    v_cvt_pk_bf16_f32 v152, v18, v19
    v_cvt_pk_bf16_f32 v153, v20, v21
    s_waitcnt lgkmcnt(8)
    v_mfma_f32_32x32x16_bf16 a[64:79], v[38:41], v[146:149], a[64:79]
    ds_read_b64_tr_b16 v[38:39], v10 offset:1824
    ds_read_b64_tr_b16 v[40:41], v10 offset:2720
    s_waitcnt vmcnt(4)
    s_barrier
    v_add_u32 v10, 133120, v8
    v_add_u32 v11, 133120, v9
    s_waitcnt lgkmcnt(8)
    v_mfma_f32_32x32x16_bf16 a[0:15], v[22:25], v[150:153], a[0:15]
    ds_read_b64_tr_b16 v[22:23], v11 offset:0
    ds_read_b64_tr_b16 v[24:25], v11 offset:256
    v_lshlrev_b32 v14, 16, v154
    v_and_b32 v15, s68, v154
    v_lshlrev_b32 v16, 16, v155
    v_and_b32 v17, s68, v155
    v_lshlrev_b32 v18, 16, v156
    s_waitcnt lgkmcnt(8)
    v_mfma_f32_32x32x16_bf16 a[16:31], v[26:29], v[150:153], a[16:31]
    ds_read_b64_tr_b16 v[26:27], v11 offset:2048
    ds_read_b64_tr_b16 v[28:29], v11 offset:2304
    v_and_b32 v19, s68, v156
    v_lshlrev_b32 v20, 16, v157
    v_and_b32 v21, s68, v157
    v_fma_f32 v14, v14, v12, v13
    v_fma_f32 v15, v15, v12, v13
    s_waitcnt lgkmcnt(8)
    v_mfma_f32_32x32x16_bf16 a[32:47], v[150:153], v[30:33], a[32:47]
    ds_read_b64_tr_b16 v[30:31], v11 offset:4096
    ds_read_b64_tr_b16 v[32:33], v11 offset:4352
    v_fma_f32 v16, v16, v12, v13
    v_fma_f32 v17, v17, v12, v13
    v_fma_f32 v18, v18, v12, v13
    v_fma_f32 v19, v19, v12, v13
    v_fma_f32 v20, v20, v12, v13
    s_waitcnt lgkmcnt(8)
    v_mfma_f32_32x32x16_bf16 a[48:63], v[34:37], v[150:153], a[48:63]
    ds_read_b64_tr_b16 v[34:35], v10 offset:0
    ds_read_b64_tr_b16 v[36:37], v10 offset:896
    v_fma_f32 v21, v21, v12, v13
    v_cvt_pk_bf16_f32 v154, v14, v15
    v_cvt_pk_bf16_f32 v155, v16, v17
    v_cvt_pk_bf16_f32 v156, v18, v19
    v_cvt_pk_bf16_f32 v157, v20, v21
    s_waitcnt lgkmcnt(8)
    v_mfma_f32_32x32x16_bf16 a[64:79], v[38:41], v[150:153], a[64:79]
    ds_read_b64_tr_b16 v[38:39], v10 offset:32
    ds_read_b64_tr_b16 v[40:41], v10 offset:928
    s_waitcnt lgkmcnt(8)
    v_mfma_f32_32x32x16_bf16 a[0:15], v[22:25], v[154:157], a[0:15]
    ds_read_b64_tr_b16 v[22:23], v11 offset:512
    ds_read_b64_tr_b16 v[24:25], v11 offset:768
    v_lshlrev_b32 v14, 16, v158
    v_and_b32 v15, s68, v158
    v_lshlrev_b32 v16, 16, v159
    v_and_b32 v17, s68, v159
    v_lshlrev_b32 v18, 16, v160
    s_waitcnt lgkmcnt(8)
    v_mfma_f32_32x32x16_bf16 a[16:31], v[26:29], v[154:157], a[16:31]
    ds_read_b64_tr_b16 v[26:27], v11 offset:2560
    ds_read_b64_tr_b16 v[28:29], v11 offset:2816
    v_and_b32 v19, s68, v160
    v_lshlrev_b32 v20, 16, v161
    v_and_b32 v21, s68, v161
    v_fma_f32 v14, v14, v12, v13
    v_fma_f32 v15, v15, v12, v13
    s_waitcnt lgkmcnt(8)
    v_mfma_f32_32x32x16_bf16 a[32:47], v[154:157], v[30:33], a[32:47]
    ds_read_b64_tr_b16 v[30:31], v11 offset:4608
    ds_read_b64_tr_b16 v[32:33], v11 offset:4864
    v_fma_f32 v16, v16, v12, v13
    v_fma_f32 v17, v17, v12, v13
    v_fma_f32 v18, v18, v12, v13
    v_fma_f32 v19, v19, v12, v13
    v_fma_f32 v20, v20, v12, v13
    s_waitcnt lgkmcnt(8)
    v_mfma_f32_32x32x16_bf16 a[48:63], v[34:37], v[154:157], a[48:63]
    ds_read_b64_tr_b16 v[34:35], v10 offset:1792
    ds_read_b64_tr_b16 v[36:37], v10 offset:2688
    v_fma_f32 v21, v21, v12, v13
    v_cvt_pk_bf16_f32 v158, v14, v15
    v_cvt_pk_bf16_f32 v159, v16, v17
    v_cvt_pk_bf16_f32 v160, v18, v19
    v_cvt_pk_bf16_f32 v161, v20, v21
    s_waitcnt lgkmcnt(8)
    v_mfma_f32_32x32x16_bf16 a[64:79], v[38:41], v[154:157], a[64:79]
    ds_read_b64_tr_b16 v[38:39], v10 offset:1824
    ds_read_b64_tr_b16 v[40:41], v10 offset:2720
    s_waitcnt vmcnt(1)
    s_barrier
    v_add_u32 v10, 0, v8
    v_add_u32 v11, 0, v9
    s_waitcnt lgkmcnt(8)
    v_mfma_f32_32x32x16_bf16 a[0:15], v[22:25], v[158:161], a[0:15]
    ds_read_b64_tr_b16 v[22:23], v11 offset:0
    ds_read_b64_tr_b16 v[24:25], v11 offset:256
    v_lshlrev_b32 v14, 16, v162
    v_and_b32 v15, s68, v162
    v_lshlrev_b32 v16, 16, v163
    v_and_b32 v17, s68, v163
    v_lshlrev_b32 v18, 16, v164
    s_waitcnt lgkmcnt(8)
    v_mfma_f32_32x32x16_bf16 a[16:31], v[26:29], v[158:161], a[16:31]
    ds_read_b64_tr_b16 v[26:27], v11 offset:2048
    ds_read_b64_tr_b16 v[28:29], v11 offset:2304
    v_and_b32 v19, s68, v164
    v_lshlrev_b32 v20, 16, v165
    v_and_b32 v21, s68, v165
    v_fma_f32 v14, v14, v12, v13
    v_fma_f32 v15, v15, v12, v13
    s_waitcnt lgkmcnt(8)
    v_mfma_f32_32x32x16_bf16 a[32:47], v[158:161], v[30:33], a[32:47]
    ds_read_b64_tr_b16 v[30:31], v11 offset:4096
    ds_read_b64_tr_b16 v[32:33], v11 offset:4352
    v_fma_f32 v16, v16, v12, v13
    v_fma_f32 v17, v17, v12, v13
    v_fma_f32 v18, v18, v12, v13
    v_fma_f32 v19, v19, v12, v13
    v_fma_f32 v20, v20, v12, v13
    s_waitcnt lgkmcnt(8)
    v_mfma_f32_32x32x16_bf16 a[48:63], v[34:37], v[158:161], a[48:63]
    ds_read_b64_tr_b16 v[34:35], v10 offset:0
    ds_read_b64_tr_b16 v[36:37], v10 offset:896
    v_fma_f32 v21, v21, v12, v13
    v_cvt_pk_bf16_f32 v162, v14, v15
    v_cvt_pk_bf16_f32 v163, v16, v17
    v_cvt_pk_bf16_f32 v164, v18, v19
    v_cvt_pk_bf16_f32 v165, v20, v21
    s_waitcnt lgkmcnt(8)
    v_mfma_f32_32x32x16_bf16 a[64:79], v[38:41], v[158:161], a[64:79]
    ds_read_b64_tr_b16 v[38:39], v10 offset:32
    ds_read_b64_tr_b16 v[40:41], v10 offset:928
    s_waitcnt lgkmcnt(8)
    v_mfma_f32_32x32x16_bf16 a[0:15], v[22:25], v[162:165], a[0:15]
    ds_read_b64_tr_b16 v[22:23], v11 offset:512
    ds_read_b64_tr_b16 v[24:25], v11 offset:768
    v_lshlrev_b32 v14, 16, v166
    v_and_b32 v15, s68, v166
    v_lshlrev_b32 v16, 16, v167
    v_and_b32 v17, s68, v167
    v_lshlrev_b32 v18, 16, v168
    s_waitcnt lgkmcnt(8)
    v_mfma_f32_32x32x16_bf16 a[16:31], v[26:29], v[162:165], a[16:31]
    ds_read_b64_tr_b16 v[26:27], v11 offset:2560
    ds_read_b64_tr_b16 v[28:29], v11 offset:2816
    v_and_b32 v19, s68, v168
    v_lshlrev_b32 v20, 16, v169
    v_and_b32 v21, s68, v169
    v_fma_f32 v14, v14, v12, v13
    v_fma_f32 v15, v15, v12, v13
    s_waitcnt lgkmcnt(8)
    v_mfma_f32_32x32x16_bf16 a[32:47], v[162:165], v[30:33], a[32:47]
    ds_read_b64_tr_b16 v[30:31], v11 offset:4608
    ds_read_b64_tr_b16 v[32:33], v11 offset:4864
    v_fma_f32 v16, v16, v12, v13
    v_fma_f32 v17, v17, v12, v13
    v_fma_f32 v18, v18, v12, v13
    v_fma_f32 v19, v19, v12, v13
    v_fma_f32 v20, v20, v12, v13
    s_waitcnt lgkmcnt(8)
    v_mfma_f32_32x32x16_bf16 a[48:63], v[34:37], v[162:165], a[48:63]
    ds_read_b64_tr_b16 v[34:35], v10 offset:1792
    ds_read_b64_tr_b16 v[36:37], v10 offset:2688
    v_fma_f32 v21, v21, v12, v13
    v_cvt_pk_bf16_f32 v166, v14, v15
    v_cvt_pk_bf16_f32 v167, v16, v17
    v_cvt_pk_bf16_f32 v168, v18, v19
    v_cvt_pk_bf16_f32 v169, v20, v21
    s_waitcnt lgkmcnt(8)
    v_mfma_f32_32x32x16_bf16 a[64:79], v[38:41], v[162:165], a[64:79]
    ds_read_b64_tr_b16 v[38:39], v10 offset:1824
    ds_read_b64_tr_b16 v[40:41], v10 offset:2720
    s_waitcnt lgkmcnt(8)
    v_mfma_f32_32x32x16_bf16 a[0:15], v[22:25], v[166:169], a[0:15]
    s_waitcnt lgkmcnt(6)
    v_mfma_f32_32x32x16_bf16 a[16:31], v[26:29], v[166:169], a[16:31]
    s_waitcnt lgkmcnt(4)
    v_mfma_f32_32x32x16_bf16 a[32:47], v[166:169], v[30:33], a[32:47]
    s_waitcnt lgkmcnt(2)
    v_mfma_f32_32x32x16_bf16 a[48:63], v[34:37], v[166:169], a[48:63]
    s_waitcnt lgkmcnt(0)
    v_mfma_f32_32x32x16_bf16 a[64:79], v[38:41], v[166:169], a[64:79]
    v_mov_b32 v14, 0xc0135761
    v_mov_b32 v15, 0xbdd2d3e8
    s_nop 7
    s_nop 3
    v_accvgpr_read_b32 v42, a48
    v_accvgpr_read_b32 v43, a49
    v_accvgpr_read_b32 v44, a50
    v_accvgpr_read_b32 v45, a51
    v_accvgpr_read_b32 v46, a52
    v_accvgpr_read_b32 v47, a53
    v_accvgpr_read_b32 v48, a54
    v_accvgpr_read_b32 v49, a55
    v_accvgpr_read_b32 v50, a56
    v_accvgpr_read_b32 v51, a57
    v_accvgpr_read_b32 v52, a58
    v_accvgpr_read_b32 v53, a59
    v_accvgpr_read_b32 v54, a60
    v_accvgpr_read_b32 v55, a61
    v_accvgpr_read_b32 v56, a62
    v_accvgpr_read_b32 v57, a63
    v_mul_f32 v58, v42, v42
    v_mul_f32 v59, v43, v43
    v_mul_f32 v60, v44, v44
    v_mul_f32 v61, v45, v45
    v_mul_f32 v62, v46, v46
    v_mul_f32 v63, v47, v47
    v_mul_f32 v64, v48, v48
    v_mul_f32 v65, v49, v49
    v_fma_f32 v58, v58, v15, v14
    v_fma_f32 v59, v59, v15, v14
    v_fma_f32 v60, v60, v15, v14
    v_fma_f32 v61, v61, v15, v14
    v_fma_f32 v62, v62, v15, v14
    v_fma_f32 v63, v63, v15, v14
    v_fma_f32 v64, v64, v15, v14
    v_fma_f32 v65, v65, v15, v14
    v_mul_f32 v58, v42, v58
    v_mul_f32 v59, v43, v59
    v_mul_f32 v60, v44, v60
    v_mul_f32 v61, v45, v61
    v_mul_f32 v62, v46, v62
    v_mul_f32 v63, v47, v63
    v_mul_f32 v64, v48, v64
    v_mul_f32 v65, v49, v65
    v_exp_f32 v58, v58
    v_exp_f32 v59, v59
    v_exp_f32 v60, v60
    v_exp_f32 v61, v61
    v_exp_f32 v62, v62
    v_exp_f32 v63, v63
    v_exp_f32 v64, v64
    v_exp_f32 v65, v65
    v_mul_f32 v50, v42, v50
    v_mul_f32 v51, v43, v51
    v_mul_f32 v52, v44, v52
    v_mul_f32 v53, v45, v53
    v_mul_f32 v54, v46, v54
    v_mul_f32 v55, v47, v55
    v_mul_f32 v56, v48, v56
    v_mul_f32 v57, v49, v57
    v_add_f32 v58, 1.0, v58
    v_add_f32 v59, 1.0, v59
    v_add_f32 v60, 1.0, v60
    v_add_f32 v61, 1.0, v61
    v_add_f32 v62, 1.0, v62
    v_add_f32 v63, 1.0, v63
    v_add_f32 v64, 1.0, v64
    v_add_f32 v65, 1.0, v65
    v_rcp_f32 v58, v58
    v_rcp_f32 v59, v59
    v_rcp_f32 v60, v60
    v_rcp_f32 v61, v61
    v_rcp_f32 v62, v62
    v_rcp_f32 v63, v63
    v_rcp_f32 v64, v64
    v_rcp_f32 v65, v65
    s_nop 0
    v_mul_f32 v50, v50, v58
    v_mul_f32 v51, v51, v59
    v_mul_f32 v52, v52, v60
    v_mul_f32 v53, v53, v61
    v_mul_f32 v54, v54, v62
    v_mul_f32 v55, v55, v63
    v_mul_f32 v56, v56, v64
    v_mul_f32 v57, v57, v65
    v_cvt_pk_bf16_f32 v42, v50, v51
    v_cvt_pk_bf16_f32 v43, v52, v53
    v_cvt_pk_bf16_f32 v44, v54, v55
    v_cvt_pk_bf16_f32 v45, v56, v57
    buffer_store_dwordx4 v[42:45], v2, s[12:15], s70 offen offset:0 sc1
    v_accvgpr_read_b32 v66, a64
    v_accvgpr_read_b32 v67, a65
    v_accvgpr_read_b32 v68, a66
    v_accvgpr_read_b32 v69, a67
    v_accvgpr_read_b32 v70, a68
    v_accvgpr_read_b32 v71, a69
    v_accvgpr_read_b32 v72, a70
    v_accvgpr_read_b32 v73, a71
    v_accvgpr_read_b32 v74, a72
    v_accvgpr_read_b32 v75, a73
    v_accvgpr_read_b32 v76, a74
    v_accvgpr_read_b32 v77, a75
    v_accvgpr_read_b32 v78, a76
    v_accvgpr_read_b32 v79, a77
    v_accvgpr_read_b32 v80, a78
    v_accvgpr_read_b32 v81, a79
    v_mul_f32 v82, v66, v66
    v_mul_f32 v83, v67, v67
    v_mul_f32 v84, v68, v68
    v_mul_f32 v85, v69, v69
    v_mul_f32 v86, v70, v70
    v_mul_f32 v87, v71, v71
    v_mul_f32 v88, v72, v72
    v_mul_f32 v89, v73, v73
    v_fma_f32 v82, v82, v15, v14
    v_fma_f32 v83, v83, v15, v14
    v_fma_f32 v84, v84, v15, v14
    v_fma_f32 v85, v85, v15, v14
    v_fma_f32 v86, v86, v15, v14
    v_fma_f32 v87, v87, v15, v14
    v_fma_f32 v88, v88, v15, v14
    v_fma_f32 v89, v89, v15, v14
    v_mul_f32 v82, v66, v82
    v_mul_f32 v83, v67, v83
    v_mul_f32 v84, v68, v84
    v_mul_f32 v85, v69, v85
    v_mul_f32 v86, v70, v86
    v_mul_f32 v87, v71, v87
    v_mul_f32 v88, v72, v88
    v_mul_f32 v89, v73, v89
    v_exp_f32 v82, v82
    v_exp_f32 v83, v83
    v_exp_f32 v84, v84
    v_exp_f32 v85, v85
    v_exp_f32 v86, v86
    v_exp_f32 v87, v87
    v_exp_f32 v88, v88
    v_exp_f32 v89, v89
    v_mul_f32 v74, v66, v74
    v_mul_f32 v75, v67, v75
    v_mul_f32 v76, v68, v76
    v_mul_f32 v77, v69, v77
    v_mul_f32 v78, v70, v78
    v_mul_f32 v79, v71, v79
    v_mul_f32 v80, v72, v80
    v_mul_f32 v81, v73, v81
    v_add_f32 v82, 1.0, v82
    v_add_f32 v83, 1.0, v83
    v_add_f32 v84, 1.0, v84
    v_add_f32 v85, 1.0, v85
    v_add_f32 v86, 1.0, v86
    v_add_f32 v87, 1.0, v87
    v_add_f32 v88, 1.0, v88
    v_add_f32 v89, 1.0, v89
    v_rcp_f32 v82, v82
    v_rcp_f32 v83, v83
    v_rcp_f32 v84, v84
    v_rcp_f32 v85, v85
    v_rcp_f32 v86, v86
    v_rcp_f32 v87, v87
    v_rcp_f32 v88, v88
    v_rcp_f32 v89, v89
    s_nop 0
    v_mul_f32 v74, v74, v82
    v_mul_f32 v75, v75, v83
    v_mul_f32 v76, v76, v84
    v_mul_f32 v77, v77, v85
    v_mul_f32 v78, v78, v86
    v_mul_f32 v79, v79, v87
    v_mul_f32 v80, v80, v88
    v_mul_f32 v81, v81, v89
    v_cvt_pk_bf16_f32 v66, v74, v75
    v_cvt_pk_bf16_f32 v67, v76, v77
    v_cvt_pk_bf16_f32 v68, v78, v79
    v_cvt_pk_bf16_f32 v69, v80, v81
    buffer_store_dwordx4 v[66:69], v2, s[12:15], s70 offen offset:1024 sc1
    s_lshl_b32 s54, s5, 7
    s_add_u32 s54, s54, s59
    s_lshl_b32 s54, s54, 10
    s_add_u32 s55, s54, 4194304
    s_add_u32 s56, s54, 65536
    s_add_u32 s57, s54, 2097152
    s_add_u32 s72, s54, 2162688
    s_mov_b32 s74, 0x3eb8aa3b
    v_accvgpr_read_b32 v90, a0
    v_accvgpr_read_b32 v91, a1
    v_accvgpr_read_b32 v92, a2
    v_accvgpr_read_b32 v93, a3
    v_accvgpr_read_b32 v94, a4
    v_accvgpr_read_b32 v95, a5
    v_accvgpr_read_b32 v96, a6
    v_accvgpr_read_b32 v97, a7
    v_mul_f32 v90, s74, v90
    v_mul_f32 v91, s74, v91
    v_mul_f32 v92, s74, v92
    v_mul_f32 v93, s74, v93
    v_mul_f32 v94, s74, v94
    v_mul_f32 v95, s74, v95
    v_mul_f32 v96, s74, v96
    v_mul_f32 v97, s74, v97
    v_cvt_pk_bf16_f32 v98, v90, v91
    v_cvt_pk_bf16_f32 v99, v92, v93
    v_cvt_pk_bf16_f32 v100, v94, v95
    v_cvt_pk_bf16_f32 v101, v96, v97
    buffer_store_dwordx4 v[98:101], v2, s[12:15], s54 offen sc1
    v_accvgpr_read_b32 v102, a8
    v_accvgpr_read_b32 v103, a9
    v_accvgpr_read_b32 v104, a10
    v_accvgpr_read_b32 v105, a11
    v_accvgpr_read_b32 v106, a12
    v_accvgpr_read_b32 v107, a13
    v_accvgpr_read_b32 v108, a14
    v_accvgpr_read_b32 v109, a15
    v_mul_f32 v102, s74, v102
    v_mul_f32 v103, s74, v103
    v_mul_f32 v104, s74, v104
    v_mul_f32 v105, s74, v105
    v_mul_f32 v106, s74, v106
    v_mul_f32 v107, s74, v107
    v_mul_f32 v108, s74, v108
    v_mul_f32 v109, s74, v109
    v_cvt_pk_bf16_f32 v110, v102, v103
    v_cvt_pk_bf16_f32 v111, v104, v105
    v_cvt_pk_bf16_f32 v112, v106, v107
    v_cvt_pk_bf16_f32 v113, v108, v109
    buffer_store_dwordx4 v[110:113], v2, s[12:15], s56 offen sc1
    v_accvgpr_read_b32 v114, a16
    v_accvgpr_read_b32 v115, a17
    v_accvgpr_read_b32 v116, a18
    v_accvgpr_read_b32 v117, a19
    v_accvgpr_read_b32 v118, a20
    v_accvgpr_read_b32 v119, a21
    v_accvgpr_read_b32 v120, a22
    v_accvgpr_read_b32 v121, a23
    v_cvt_pk_bf16_f32 v122, v114, v115
    v_cvt_pk_bf16_f32 v123, v116, v117
    v_cvt_pk_bf16_f32 v124, v118, v119
    v_cvt_pk_bf16_f32 v125, v120, v121
    buffer_store_dwordx4 v[122:125], v2, s[12:15], s57 offen sc1
    v_accvgpr_read_b32 v126, a24
    v_accvgpr_read_b32 v127, a25
    v_accvgpr_read_b32 v128, a26
    v_accvgpr_read_b32 v129, a27
    v_accvgpr_read_b32 v130, a28
    v_accvgpr_read_b32 v131, a29
    v_accvgpr_read_b32 v132, a30
    v_accvgpr_read_b32 v133, a31
    v_cvt_pk_bf16_f32 v134, v126, v127
    v_cvt_pk_bf16_f32 v135, v128, v129
    v_cvt_pk_bf16_f32 v136, v130, v131
    v_cvt_pk_bf16_f32 v137, v132, v133
    buffer_store_dwordx4 v[134:137], v2, s[12:15], s72 offen sc1
    v_accvgpr_read_b32 v138, a32
    v_accvgpr_read_b32 v139, a33
    v_accvgpr_read_b32 v140, a34
    v_accvgpr_read_b32 v141, a35
    v_accvgpr_read_b32 v142, a36
    v_accvgpr_read_b32 v143, a37
    v_accvgpr_read_b32 v144, a38
    v_accvgpr_read_b32 v145, a39
    v_cvt_pk_bf16_f32 v146, v138, v139
    v_cvt_pk_bf16_f32 v147, v140, v141
    v_cvt_pk_bf16_f32 v148, v142, v143
    v_cvt_pk_bf16_f32 v149, v144, v145
    buffer_store_dwordx4 v[146:149], v4, s[12:15], s55 offen offset:0 sc1
    v_accvgpr_read_b32 v150, a40
    v_accvgpr_read_b32 v151, a41
    v_accvgpr_read_b32 v152, a42
    v_accvgpr_read_b32 v153, a43
    v_accvgpr_read_b32 v154, a44
    v_accvgpr_read_b32 v155, a45
    v_accvgpr_read_b32 v156, a46
    v_accvgpr_read_b32 v157, a47
    v_cvt_pk_bf16_f32 v158, v150, v151
    v_cvt_pk_bf16_f32 v159, v152, v153
    v_cvt_pk_bf16_f32 v160, v154, v155
    v_cvt_pk_bf16_f32 v161, v156, v157
    buffer_store_dwordx4 v[158:161], v4, s[12:15], s55 offen offset:512 sc1
    s_endpgm
k1_kernel_main1:
    s_waitcnt vmcnt(6)
    s_barrier
    v_add_u32 v10, 133120, v8
    v_add_u32 v11, 133120, v9
    ds_read_b64_tr_b16 v[22:23], v10 offset:64
    ds_read_b64_tr_b16 v[24:25], v10 offset:960
    ds_read_b64_tr_b16 v[26:27], v10 offset:96
    ds_read_b64_tr_b16 v[28:29], v10 offset:992
    ds_read_b64_tr_b16 v[30:31], v10 offset:128
    ds_read_b64_tr_b16 v[32:33], v10 offset:1024
    ds_read_b64_tr_b16 v[34:35], v10 offset:160
    ds_read_b64_tr_b16 v[36:37], v10 offset:1056
    ds_read_b64_tr_b16 v[38:39], v10 offset:192
    ds_read_b64_tr_b16 v[40:41], v10 offset:1088
    s_waitcnt lgkmcnt(8)
    v_mfma_f32_32x32x16_bf16 a[0:15], v[22:25], v[42:45], 0
    ds_read_b64_tr_b16 v[22:23], v10 offset:1856
    ds_read_b64_tr_b16 v[24:25], v10 offset:2752
    s_add_u32 m0, s36, 41472
    s_nop 0
    buffer_load_dwordx4 v5, s[24:27], s60 offen lds
    s_add_u32 s60, s60, s64
    v_lshlrev_b32 v14, 16, v46
    v_and_b32 v15, s68, v46
    v_lshlrev_b32 v16, 16, v47
    v_and_b32 v17, s68, v47
    v_lshlrev_b32 v18, 16, v48
    s_waitcnt lgkmcnt(8)
    v_mfma_f32_32x32x16_bf16 a[16:31], v[26:29], v[42:45], 0
    ds_read_b64_tr_b16 v[26:27], v10 offset:1888
    ds_read_b64_tr_b16 v[28:29], v10 offset:2784
    s_add_u32 m0, s37, 41472
    s_nop 0
    buffer_load_dwordx4 v6, s[28:31], s61 offen lds
    s_add_u32 s61, s61, s65
    v_and_b32 v19, s68, v48
    v_lshlrev_b32 v20, 16, v49
    v_and_b32 v21, s68, v49
    v_fma_f32 v14, v14, v12, v13
    v_fma_f32 v15, v15, v12, v13
    s_waitcnt lgkmcnt(8)
    v_mfma_f32_32x32x16_bf16 a[32:47], v[30:33], v[42:45], 0
    ds_read_b64_tr_b16 v[30:31], v10 offset:1920
    ds_read_b64_tr_b16 v[32:33], v10 offset:2816
    s_add_u32 s57, s38, 41472
    s_cmp_eq_u32 s75, 1
    s_cselect_b32 m0, 153856, s57
    s_nop 0
    buffer_load_dwordx4 v7, s[32:35], s62 offen lds
    s_add_u32 s62, s62, s66
    v_fma_f32 v16, v16, v12, v13
    v_fma_f32 v17, v17, v12, v13
    v_fma_f32 v18, v18, v12, v13
    v_fma_f32 v19, v19, v12, v13
    v_fma_f32 v20, v20, v12, v13
    s_waitcnt lgkmcnt(8)
    v_mfma_f32_32x32x16_bf16 a[48:63], v[34:37], v[42:45], 0
    ds_read_b64_tr_b16 v[34:35], v10 offset:1952
    ds_read_b64_tr_b16 v[36:37], v10 offset:2848
    v_fma_f32 v21, v21, v12, v13
    v_cvt_pk_bf16_f32 v46, v14, v15
    v_cvt_pk_bf16_f32 v47, v16, v17
    v_cvt_pk_bf16_f32 v48, v18, v19
    v_cvt_pk_bf16_f32 v49, v20, v21
    s_waitcnt lgkmcnt(8)
    v_mfma_f32_32x32x16_bf16 a[64:79], v[38:41], v[42:45], 0
    ds_read_b64_tr_b16 v[38:39], v10 offset:1984
    ds_read_b64_tr_b16 v[40:41], v10 offset:2880
    s_waitcnt vmcnt(6)
    s_barrier
    v_add_u32 v10, 0, v8
    v_add_u32 v11, 0, v9
    s_waitcnt lgkmcnt(8)
    v_mfma_f32_32x32x16_bf16 a[0:15], v[22:25], v[46:49], a[0:15]
    ds_read_b64_tr_b16 v[22:23], v10 offset:64
    ds_read_b64_tr_b16 v[24:25], v10 offset:960
    s_add_u32 m0, s36, 62208
    s_nop 0
    buffer_load_dwordx4 v5, s[24:27], s60 offen lds
    s_add_u32 s60, s60, s64
    v_lshlrev_b32 v14, 16, v50
    v_and_b32 v15, s68, v50
    v_lshlrev_b32 v16, 16, v51
    v_and_b32 v17, s68, v51
    v_lshlrev_b32 v18, 16, v52
    s_waitcnt lgkmcnt(8)
    v_mfma_f32_32x32x16_bf16 a[16:31], v[26:29], v[46:49], a[16:31]
    ds_read_b64_tr_b16 v[26:27], v10 offset:96
    ds_read_b64_tr_b16 v[28:29], v10 offset:992
    s_add_u32 m0, s37, 62208
    s_nop 0
    buffer_load_dwordx4 v6, s[28:31], s61 offen lds
    s_add_u32 s61, s61, s65
    v_and_b32 v19, s68, v52
    v_lshlrev_b32 v20, 16, v53
    v_and_b32 v21, s68, v53
    v_fma_f32 v14, v14, v12, v13
    v_fma_f32 v15, v15, v12, v13
    s_waitcnt lgkmcnt(8)
    v_mfma_f32_32x32x16_bf16 a[32:47], v[30:33], v[46:49], a[32:47]
    ds_read_b64_tr_b16 v[30:31], v10 offset:128
    ds_read_b64_tr_b16 v[32:33], v10 offset:1024
    s_add_u32 s57, s38, 62208
    s_cmp_eq_u32 s75, 1
    s_cselect_b32 m0, 153856, s57
    s_nop 0
    buffer_load_dwordx4 v7, s[32:35], s62 offen lds
    s_add_u32 s62, s62, s66
    v_fma_f32 v16, v16, v12, v13
    v_fma_f32 v17, v17, v12, v13
    v_fma_f32 v18, v18, v12, v13
    v_fma_f32 v19, v19, v12, v13
    v_fma_f32 v20, v20, v12, v13
    s_waitcnt lgkmcnt(8)
    v_mfma_f32_32x32x16_bf16 a[48:63], v[34:37], v[46:49], a[48:63]
    ds_read_b64_tr_b16 v[34:35], v10 offset:160
    ds_read_b64_tr_b16 v[36:37], v10 offset:1056
    v_fma_f32 v21, v21, v12, v13
    v_cvt_pk_bf16_f32 v50, v14, v15
    v_cvt_pk_bf16_f32 v51, v16, v17
    v_cvt_pk_bf16_f32 v52, v18, v19
    v_cvt_pk_bf16_f32 v53, v20, v21
    s_waitcnt lgkmcnt(8)
    v_mfma_f32_32x32x16_bf16 a[64:79], v[38:41], v[46:49], a[64:79]
    ds_read_b64_tr_b16 v[38:39], v10 offset:192
    ds_read_b64_tr_b16 v[40:41], v10 offset:1088
    s_waitcnt lgkmcnt(8)
    v_mfma_f32_32x32x16_bf16 a[0:15], v[22:25], v[50:53], a[0:15]
    ds_read_b64_tr_b16 v[22:23], v10 offset:1856
    ds_read_b64_tr_b16 v[24:25], v10 offset:2752
    s_add_u32 m0, s36, 82944
    s_nop 0
    buffer_load_dwordx4 v5, s[24:27], s60 offen lds
    s_add_u32 s60, s60, s64
    v_lshlrev_b32 v14, 16, v54
    v_and_b32 v15, s68, v54
    v_lshlrev_b32 v16, 16, v55
    v_and_b32 v17, s68, v55
    v_lshlrev_b32 v18, 16, v56
    s_waitcnt lgkmcnt(8)
    v_mfma_f32_32x32x16_bf16 a[16:31], v[26:29], v[50:53], a[16:31]
    ds_read_b64_tr_b16 v[26:27], v10 offset:1888
    ds_read_b64_tr_b16 v[28:29], v10 offset:2784
    s_add_u32 m0, s37, 82944
    s_nop 0
    buffer_load_dwordx4 v6, s[28:31], s61 offen lds
    s_add_u32 s61, s61, s65
    v_and_b32 v19, s68, v56
    v_lshlrev_b32 v20, 16, v57
    v_and_b32 v21, s68, v57
    v_fma_f32 v14, v14, v12, v13
    v_fma_f32 v15, v15, v12, v13
    s_waitcnt lgkmcnt(8)
    v_mfma_f32_32x32x16_bf16 a[32:47], v[30:33], v[50:53], a[32:47]
    ds_read_b64_tr_b16 v[30:31], v10 offset:1920
    ds_read_b64_tr_b16 v[32:33], v10 offset:2816
    s_add_u32 s57, s38, 82944
    s_cmp_eq_u32 s75, 1
    s_cselect_b32 m0, 153856, s57
    s_nop 0
    buffer_load_dwordx4 v7, s[32:35], s62 offen lds
    s_add_u32 s62, s62, s66
    v_fma_f32 v16, v16, v12, v13
    v_fma_f32 v17, v17, v12, v13
    v_fma_f32 v18, v18, v12, v13
    v_fma_f32 v19, v19, v12, v13
    v_fma_f32 v20, v20, v12, v13
    s_waitcnt lgkmcnt(8)
    v_mfma_f32_32x32x16_bf16 a[48:63], v[34:37], v[50:53], a[48:63]
    ds_read_b64_tr_b16 v[34:35], v10 offset:1952
    ds_read_b64_tr_b16 v[36:37], v10 offset:2848
    v_fma_f32 v21, v21, v12, v13
    v_cvt_pk_bf16_f32 v54, v14, v15
    v_cvt_pk_bf16_f32 v55, v16, v17
    v_cvt_pk_bf16_f32 v56, v18, v19
    v_cvt_pk_bf16_f32 v57, v20, v21
    s_waitcnt lgkmcnt(8)
    v_mfma_f32_32x32x16_bf16 a[64:79], v[38:41], v[50:53], a[64:79]
    ds_read_b64_tr_b16 v[38:39], v10 offset:1984
    ds_read_b64_tr_b16 v[40:41], v10 offset:2880
    s_waitcnt vmcnt(9)
    s_barrier
    v_add_u32 v10, 20736, v8
    v_add_u32 v11, 20736, v9
    s_waitcnt lgkmcnt(8)
    v_mfma_f32_32x32x16_bf16 a[0:15], v[22:25], v[54:57], a[0:15]
    ds_read_b64_tr_b16 v[22:23], v10 offset:64
    ds_read_b64_tr_b16 v[24:25], v10 offset:960
    s_add_u32 m0, s36, 103680
    s_nop 0
    buffer_load_dwordx4 v5, s[24:27], s60 offen lds
    s_add_u32 s60, s60, s64
    s_add_u32 m0, s37, 103680
    s_nop 0
    buffer_load_dwordx4 v6, s[28:31], s61 offen lds
    s_add_u32 s61, s61, s65
    v_lshlrev_b32 v14, 16, v58
    v_and_b32 v15, s68, v58
    v_lshlrev_b32 v16, 16, v59
    v_and_b32 v17, s68, v59
    v_lshlrev_b32 v18, 16, v60
    s_waitcnt lgkmcnt(8)
    v_mfma_f32_32x32x16_bf16 a[16:31], v[26:29], v[54:57], a[16:31]
    ds_read_b64_tr_b16 v[26:27], v10 offset:96
    ds_read_b64_tr_b16 v[28:29], v10 offset:992
    s_add_u32 s57, s38, 103680
    s_cmp_eq_u32 s75, 1
    s_cselect_b32 m0, 153856, s57
    s_nop 0
    buffer_load_dwordx4 v7, s[32:35], s62 offen lds
    s_add_u32 s62, s62, s66
    v_and_b32 v19, s68, v60
    v_lshlrev_b32 v20, 16, v61
    v_and_b32 v21, s68, v61
    v_fma_f32 v14, v14, v12, v13
    v_fma_f32 v15, v15, v12, v13
    s_waitcnt lgkmcnt(8)
    v_mfma_f32_32x32x16_bf16 a[32:47], v[30:33], v[54:57], a[32:47]
    ds_read_b64_tr_b16 v[30:31], v10 offset:128
    ds_read_b64_tr_b16 v[32:33], v10 offset:1024
    s_add_u32 m0, s36, 133120
    s_nop 0
    buffer_load_dwordx4 v5, s[24:27], s60 offen lds
    s_add_u32 s60, s60, s64
    v_fma_f32 v16, v16, v12, v13
    v_fma_f32 v17, v17, v12, v13
    v_fma_f32 v18, v18, v12, v13
    v_fma_f32 v19, v19, v12, v13
    v_fma_f32 v20, v20, v12, v13
    s_waitcnt lgkmcnt(8)
    v_mfma_f32_32x32x16_bf16 a[48:63], v[34:37], v[54:57], a[48:63]
    ds_read_b64_tr_b16 v[34:35], v10 offset:160
    ds_read_b64_tr_b16 v[36:37], v10 offset:1056
    s_add_u32 m0, s37, 133120
    s_nop 0
    buffer_load_dwordx4 v6, s[28:31], s61 offen lds
    s_add_u32 s61, s61, s65
    v_fma_f32 v21, v21, v12, v13
    v_cvt_pk_bf16_f32 v58, v14, v15
    v_cvt_pk_bf16_f32 v59, v16, v17
    v_cvt_pk_bf16_f32 v60, v18, v19
    v_cvt_pk_bf16_f32 v61, v20, v21
    s_waitcnt lgkmcnt(8)
    v_mfma_f32_32x32x16_bf16 a[64:79], v[38:41], v[54:57], a[64:79]
    ds_read_b64_tr_b16 v[38:39], v10 offset:192
    ds_read_b64_tr_b16 v[40:41], v10 offset:1088
    s_add_u32 s57, s38, 133120
    s_cmp_eq_u32 s75, 1
    s_cselect_b32 m0, 153856, s57
    s_nop 0
    buffer_load_dwordx4 v7, s[32:35], s62 offen lds
    s_add_u32 s62, s62, s66
    s_waitcnt lgkmcnt(8)
    v_mfma_f32_32x32x16_bf16 a[0:15], v[22:25], v[58:61], a[0:15]
    ds_read_b64_tr_b16 v[22:23], v10 offset:1856
    ds_read_b64_tr_b16 v[24:25], v10 offset:2752
    v_lshlrev_b32 v14, 16, v62
    v_and_b32 v15, s68, v62
    v_lshlrev_b32 v16, 16, v63
    v_and_b32 v17, s68, v63
    v_lshlrev_b32 v18, 16, v64
    s_waitcnt lgkmcnt(8)
    v_mfma_f32_32x32x16_bf16 a[16:31], v[26:29], v[58:61], a[16:31]
    ds_read_b64_tr_b16 v[26:27], v10 offset:1888
    ds_read_b64_tr_b16 v[28:29], v10 offset:2784
    v_and_b32 v19, s68, v64
    v_lshlrev_b32 v20, 16, v65
    v_and_b32 v21, s68, v65
    v_fma_f32 v14, v14, v12, v13
    v_fma_f32 v15, v15, v12, v13
    s_waitcnt lgkmcnt(8)
    v_mfma_f32_32x32x16_bf16 a[32:47], v[30:33], v[58:61], a[32:47]
    ds_read_b64_tr_b16 v[30:31], v10 offset:1920
    ds_read_b64_tr_b16 v[32:33], v10 offset:2816
    v_fma_f32 v16, v16, v12, v13
    v_fma_f32 v17, v17, v12, v13
    v_fma_f32 v18, v18, v12, v13
    v_fma_f32 v19, v19, v12, v13
    v_fma_f32 v20, v20, v12, v13
    s_waitcnt lgkmcnt(8)
    v_mfma_f32_32x32x16_bf16 a[48:63], v[34:37], v[58:61], a[48:63]
    ds_read_b64_tr_b16 v[34:35], v10 offset:1952
    ds_read_b64_tr_b16 v[36:37], v10 offset:2848
    v_fma_f32 v21, v21, v12, v13
    v_cvt_pk_bf16_f32 v62, v14, v15
    v_cvt_pk_bf16_f32 v63, v16, v17
    v_cvt_pk_bf16_f32 v64, v18, v19
    v_cvt_pk_bf16_f32 v65, v20, v21
    s_waitcnt lgkmcnt(8)
    v_mfma_f32_32x32x16_bf16 a[64:79], v[38:41], v[58:61], a[64:79]
    ds_read_b64_tr_b16 v[38:39], v10 offset:1984
    ds_read_b64_tr_b16 v[40:41], v10 offset:2880
    s_waitcnt vmcnt(12)
    s_barrier
    v_add_u32 v10, 41472, v8
    v_add_u32 v11, 41472, v9
    s_waitcnt lgkmcnt(8)
    v_mfma_f32_32x32x16_bf16 a[0:15], v[22:25], v[62:65], a[0:15]
    ds_read_b64_tr_b16 v[22:23], v10 offset:64
    ds_read_b64_tr_b16 v[24:25], v10 offset:960
    s_add_u32 m0, s36, 0
    s_nop 0
    buffer_load_dwordx4 v5, s[24:27], s60 offen lds
    s_add_u32 s60, s60, s64
    v_lshlrev_b32 v14, 16, v66
    v_and_b32 v15, s68, v66
    v_lshlrev_b32 v16, 16, v67
    v_and_b32 v17, s68, v67
    v_lshlrev_b32 v18, 16, v68
    s_waitcnt lgkmcnt(8)
    v_mfma_f32_32x32x16_bf16 a[16:31], v[26:29], v[62:65], a[16:31]
    ds_read_b64_tr_b16 v[26:27], v10 offset:96
    ds_read_b64_tr_b16 v[28:29], v10 offset:992
    s_add_u32 m0, s37, 0
    s_nop 0
    buffer_load_dwordx4 v6, s[28:31], s61 offen lds
    s_add_u32 s61, s61, s65
    v_and_b32 v19, s68, v68
    v_lshlrev_b32 v20, 16, v69
    v_and_b32 v21, s68, v69
    v_fma_f32 v14, v14, v12, v13
    v_fma_f32 v15, v15, v12, v13
    s_waitcnt lgkmcnt(8)
    v_mfma_f32_32x32x16_bf16 a[32:47], v[30:33], v[62:65], a[32:47]
    ds_read_b64_tr_b16 v[30:31], v10 offset:128
    ds_read_b64_tr_b16 v[32:33], v10 offset:1024
    s_add_u32 s57, s38, 0
    s_cmp_eq_u32 s75, 1
    s_cselect_b32 m0, 153856, s57
    s_nop 0
    buffer_load_dwordx4 v7, s[32:35], s62 offen lds
    s_add_u32 s62, s62, s66
    v_fma_f32 v16, v16, v12, v13
    v_fma_f32 v17, v17, v12, v13
    v_fma_f32 v18, v18, v12, v13
    v_fma_f32 v19, v19, v12, v13
    v_fma_f32 v20, v20, v12, v13
    s_waitcnt lgkmcnt(8)
    v_mfma_f32_32x32x16_bf16 a[48:63], v[34:37], v[62:65], a[48:63]
    ds_read_b64_tr_b16 v[34:35], v10 offset:160
    ds_read_b64_tr_b16 v[36:37], v10 offset:1056
    v_fma_f32 v21, v21, v12, v13
    v_cvt_pk_bf16_f32 v66, v14, v15
    v_cvt_pk_bf16_f32 v67, v16, v17
    v_cvt_pk_bf16_f32 v68, v18, v19
    v_cvt_pk_bf16_f32 v69, v20, v21
    s_waitcnt lgkmcnt(8)
    v_mfma_f32_32x32x16_bf16 a[64:79], v[38:41], v[62:65], a[64:79]
    ds_read_b64_tr_b16 v[38:39], v10 offset:192
    ds_read_b64_tr_b16 v[40:41], v10 offset:1088
    s_waitcnt lgkmcnt(8)
    v_mfma_f32_32x32x16_bf16 a[0:15], v[22:25], v[66:69], a[0:15]
    ds_read_b64_tr_b16 v[22:23], v10 offset:1856
    ds_read_b64_tr_b16 v[24:25], v10 offset:2752
    v_lshlrev_b32 v14, 16, v70
    v_and_b32 v15, s68, v70
    v_lshlrev_b32 v16, 16, v71
    v_and_b32 v17, s68, v71
    v_lshlrev_b32 v18, 16, v72
    s_waitcnt lgkmcnt(8)
    v_mfma_f32_32x32x16_bf16 a[16:31], v[26:29], v[66:69], a[16:31]
    ds_read_b64_tr_b16 v[26:27], v10 offset:1888
    ds_read_b64_tr_b16 v[28:29], v10 offset:2784
    v_and_b32 v19, s68, v72
    v_lshlrev_b32 v20, 16, v73
    v_and_b32 v21, s68, v73
    v_fma_f32 v14, v14, v12, v13
    v_fma_f32 v15, v15, v12, v13
    s_waitcnt lgkmcnt(8)
    v_mfma_f32_32x32x16_bf16 a[32:47], v[30:33], v[66:69], a[32:47]
    ds_read_b64_tr_b16 v[30:31], v10 offset:1920
    ds_read_b64_tr_b16 v[32:33], v10 offset:2816
    v_fma_f32 v16, v16, v12, v13
    v_fma_f32 v17, v17, v12, v13
    v_fma_f32 v18, v18, v12, v13
    v_fma_f32 v19, v19, v12, v13
    v_fma_f32 v20, v20, v12, v13
    s_waitcnt lgkmcnt(8)
    v_mfma_f32_32x32x16_bf16 a[48:63], v[34:37], v[66:69], a[48:63]
    ds_read_b64_tr_b16 v[34:35], v10 offset:1952
    ds_read_b64_tr_b16 v[36:37], v10 offset:2848
    v_fma_f32 v21, v21, v12, v13
    v_cvt_pk_bf16_f32 v70, v14, v15
    v_cvt_pk_bf16_f32 v71, v16, v17
    v_cvt_pk_bf16_f32 v72, v18, v19
    v_cvt_pk_bf16_f32 v73, v20, v21
    s_waitcnt lgkmcnt(8)
    v_mfma_f32_32x32x16_bf16 a[64:79], v[38:41], v[66:69], a[64:79]
    ds_read_b64_tr_b16 v[38:39], v10 offset:1984
    ds_read_b64_tr_b16 v[40:41], v10 offset:2880
    s_waitcnt vmcnt(12)
    s_barrier
    v_add_u32 v10, 62208, v8
    v_add_u32 v11, 62208, v9
    s_waitcnt lgkmcnt(8)
    v_mfma_f32_32x32x16_bf16 a[0:15], v[22:25], v[70:73], a[0:15]
    ds_read_b64_tr_b16 v[22:23], v10 offset:64
    ds_read_b64_tr_b16 v[24:25], v10 offset:960
    s_add_u32 m0, s36, 20736
    s_nop 0
    buffer_load_dwordx4 v5, s[24:27], s60 offen lds
    s_add_u32 s60, s60, s64
    v_lshlrev_b32 v14, 16, v74
    v_and_b32 v15, s68, v74
    v_lshlrev_b32 v16, 16, v75
    v_and_b32 v17, s68, v75
    v_lshlrev_b32 v18, 16, v76
    s_waitcnt lgkmcnt(8)
    v_mfma_f32_32x32x16_bf16 a[16:31], v[26:29], v[70:73], a[16:31]
    ds_read_b64_tr_b16 v[26:27], v10 offset:96
    ds_read_b64_tr_b16 v[28:29], v10 offset:992
    s_add_u32 m0, s37, 20736
    s_nop 0
    buffer_load_dwordx4 v6, s[28:31], s61 offen lds
    s_add_u32 s61, s61, s65
    v_and_b32 v19, s68, v76
    v_lshlrev_b32 v20, 16, v77
    v_and_b32 v21, s68, v77
    v_fma_f32 v14, v14, v12, v13
    v_fma_f32 v15, v15, v12, v13
    s_waitcnt lgkmcnt(8)
    v_mfma_f32_32x32x16_bf16 a[32:47], v[30:33], v[70:73], a[32:47]
    ds_read_b64_tr_b16 v[30:31], v10 offset:128
    ds_read_b64_tr_b16 v[32:33], v10 offset:1024
    s_add_u32 s57, s38, 20736
    s_cmp_eq_u32 s75, 1
    s_cselect_b32 m0, 153856, s57
    s_nop 0
    buffer_load_dwordx4 v7, s[32:35], s62 offen lds
    s_add_u32 s62, s62, s66
    v_fma_f32 v16, v16, v12, v13
    v_fma_f32 v17, v17, v12, v13
    v_fma_f32 v18, v18, v12, v13
    v_fma_f32 v19, v19, v12, v13
    v_fma_f32 v20, v20, v12, v13
    s_waitcnt lgkmcnt(8)
    v_mfma_f32_32x32x16_bf16 a[48:63], v[34:37], v[70:73], a[48:63]
    ds_read_b64_tr_b16 v[34:35], v10 offset:160
    ds_read_b64_tr_b16 v[36:37], v10 offset:1056
    v_fma_f32 v21, v21, v12, v13
    v_cvt_pk_bf16_f32 v74, v14, v15
    v_cvt_pk_bf16_f32 v75, v16, v17
    v_cvt_pk_bf16_f32 v76, v18, v19
    v_cvt_pk_bf16_f32 v77, v20, v21
    s_waitcnt lgkmcnt(8)
    v_mfma_f32_32x32x16_bf16 a[64:79], v[38:41], v[70:73], a[64:79]
    ds_read_b64_tr_b16 v[38:39], v10 offset:192
    ds_read_b64_tr_b16 v[40:41], v10 offset:1088
    s_add_u32 s55, s73, 0
    s_lshr_b32 s56, s55, 4
    s_and_b32 s55, s55, 15
    s_mul_i32 s72, s55, 144
    s_add_u32 s72, s72, s56
    s_lshl_b32 s72, s72, 10
    s_add_u32 s72, s72, 10485760
    s_mov_b32 s18, 524288
    s_cmp_lt_u32 s56, 112
    s_cselect_b32 s16, s50, s48
    s_cselect_b32 s17, s51, s49
    s_cselect_b32 s18, 1835008, s18
    s_cselect_b32 s54, 0, 112
    s_and_b32 s17, s17, 0xffff
    s_mov_b32 s19, 0x00020000
    s_sub_u32 s56, s56, s54
    s_lshl_b32 s56, s56, 14
    s_mov_b32 m0, s74
    s_lshl_b32 s55, s55, 6
    s_add_u32 s56, s56, s55
    buffer_load_dwordx4 v170, s[16:19], s56 offen lds
    s_waitcnt lgkmcnt(8)
    v_mfma_f32_32x32x16_bf16 a[0:15], v[22:25], v[74:77], a[0:15]
    ds_read_b64_tr_b16 v[22:23], v10 offset:1856
    ds_read_b64_tr_b16 v[24:25], v10 offset:2752
    v_lshlrev_b32 v14, 16, v78
    v_and_b32 v15, s68, v78
    v_lshlrev_b32 v16, 16, v79
    v_and_b32 v17, s68, v79
    v_lshlrev_b32 v18, 16, v80
    s_waitcnt lgkmcnt(8)
    v_mfma_f32_32x32x16_bf16 a[16:31], v[26:29], v[74:77], a[16:31]
    ds_read_b64_tr_b16 v[26:27], v10 offset:1888
    ds_read_b64_tr_b16 v[28:29], v10 offset:2784
    v_and_b32 v19, s68, v80
    v_lshlrev_b32 v20, 16, v81
    v_and_b32 v21, s68, v81
    v_fma_f32 v14, v14, v12, v13
    v_fma_f32 v15, v15, v12, v13
    s_waitcnt lgkmcnt(8)
    v_mfma_f32_32x32x16_bf16 a[32:47], v[30:33], v[74:77], a[32:47]
    ds_read_b64_tr_b16 v[30:31], v10 offset:1920
    ds_read_b64_tr_b16 v[32:33], v10 offset:2816
    v_fma_f32 v16, v16, v12, v13
    v_fma_f32 v17, v17, v12, v13
    v_fma_f32 v18, v18, v12, v13
    v_fma_f32 v19, v19, v12, v13
    v_fma_f32 v20, v20, v12, v13
    s_waitcnt lgkmcnt(8)
    v_mfma_f32_32x32x16_bf16 a[48:63], v[34:37], v[74:77], a[48:63]
    ds_read_b64_tr_b16 v[34:35], v10 offset:1952
    ds_read_b64_tr_b16 v[36:37], v10 offset:2848
    v_fma_f32 v21, v21, v12, v13
    v_cvt_pk_bf16_f32 v78, v14, v15
    v_cvt_pk_bf16_f32 v79, v16, v17
    v_cvt_pk_bf16_f32 v80, v18, v19
    v_cvt_pk_bf16_f32 v81, v20, v21
    s_waitcnt lgkmcnt(8)
    v_mfma_f32_32x32x16_bf16 a[64:79], v[38:41], v[74:77], a[64:79]
    ds_read_b64_tr_b16 v[38:39], v10 offset:1984
    ds_read_b64_tr_b16 v[40:41], v10 offset:2880
    s_waitcnt vmcnt(13)
    s_barrier
    v_add_u32 v10, 82944, v8
    v_add_u32 v11, 82944, v9
    s_waitcnt lgkmcnt(8)
    v_mfma_f32_32x32x16_bf16 a[0:15], v[22:25], v[78:81], a[0:15]
    ds_read_b64_tr_b16 v[22:23], v10 offset:64
    ds_read_b64_tr_b16 v[24:25], v10 offset:960
    s_add_u32 m0, s36, 41472
    s_nop 0
    buffer_load_dwordx4 v5, s[24:27], s60 offen lds
    s_add_u32 s60, s60, s64
    v_lshlrev_b32 v14, 16, v82
    v_and_b32 v15, s68, v82
    v_lshlrev_b32 v16, 16, v83
    v_and_b32 v17, s68, v83
    v_lshlrev_b32 v18, 16, v84
    s_waitcnt lgkmcnt(8)
    v_mfma_f32_32x32x16_bf16 a[16:31], v[26:29], v[78:81], a[16:31]
    ds_read_b64_tr_b16 v[26:27], v10 offset:96
    ds_read_b64_tr_b16 v[28:29], v10 offset:992
    s_add_u32 m0, s37, 41472
    s_nop 0
    buffer_load_dwordx4 v6, s[28:31], s61 offen lds
    s_add_u32 s61, s61, s65
    v_and_b32 v19, s68, v84
    v_lshlrev_b32 v20, 16, v85
    v_and_b32 v21, s68, v85
    v_fma_f32 v14, v14, v12, v13
    v_fma_f32 v15, v15, v12, v13
    s_waitcnt lgkmcnt(8)
    v_mfma_f32_32x32x16_bf16 a[32:47], v[30:33], v[78:81], a[32:47]
    ds_read_b64_tr_b16 v[30:31], v10 offset:128
    ds_read_b64_tr_b16 v[32:33], v10 offset:1024
    s_add_u32 s57, s38, 41472
    s_cmp_eq_u32 s75, 1
    s_cselect_b32 m0, 153856, s57
    s_nop 0
    buffer_load_dwordx4 v7, s[32:35], s62 offen lds
    s_add_u32 s62, s62, s66
    v_fma_f32 v16, v16, v12, v13
    v_fma_f32 v17, v17, v12, v13
    v_fma_f32 v18, v18, v12, v13
    v_fma_f32 v19, v19, v12, v13
    v_fma_f32 v20, v20, v12, v13
    s_waitcnt lgkmcnt(8)
    v_mfma_f32_32x32x16_bf16 a[48:63], v[34:37], v[78:81], a[48:63]
    ds_read_b64_tr_b16 v[34:35], v10 offset:160
    ds_read_b64_tr_b16 v[36:37], v10 offset:1056
    v_fma_f32 v21, v21, v12, v13
    v_cvt_pk_bf16_f32 v82, v14, v15
    v_cvt_pk_bf16_f32 v83, v16, v17
    v_cvt_pk_bf16_f32 v84, v18, v19
    v_cvt_pk_bf16_f32 v85, v20, v21
    s_waitcnt lgkmcnt(8)
    v_mfma_f32_32x32x16_bf16 a[64:79], v[38:41], v[78:81], a[64:79]
    ds_read_b64_tr_b16 v[38:39], v10 offset:192
    ds_read_b64_tr_b16 v[40:41], v10 offset:1088
    s_waitcnt lgkmcnt(8)
    v_mfma_f32_32x32x16_bf16 a[0:15], v[22:25], v[82:85], a[0:15]
    ds_read_b64_tr_b16 v[22:23], v10 offset:1856
    ds_read_b64_tr_b16 v[24:25], v10 offset:2752
    v_lshlrev_b32 v14, 16, v86
    v_and_b32 v15, s68, v86
    v_lshlrev_b32 v16, 16, v87
    v_and_b32 v17, s68, v87
    v_lshlrev_b32 v18, 16, v88
    s_waitcnt lgkmcnt(8)
    v_mfma_f32_32x32x16_bf16 a[16:31], v[26:29], v[82:85], a[16:31]
    ds_read_b64_tr_b16 v[26:27], v10 offset:1888
    ds_read_b64_tr_b16 v[28:29], v10 offset:2784
    v_and_b32 v19, s68, v88
    v_lshlrev_b32 v20, 16, v89
    v_and_b32 v21, s68, v89
    v_fma_f32 v14, v14, v12, v13
    v_fma_f32 v15, v15, v12, v13
    s_waitcnt lgkmcnt(8)
    v_mfma_f32_32x32x16_bf16 a[32:47], v[30:33], v[82:85], a[32:47]
    ds_read_b64_tr_b16 v[30:31], v10 offset:1920
    ds_read_b64_tr_b16 v[32:33], v10 offset:2816
    v_fma_f32 v16, v16, v12, v13
    v_fma_f32 v17, v17, v12, v13
    v_fma_f32 v18, v18, v12, v13
    v_fma_f32 v19, v19, v12, v13
    v_fma_f32 v20, v20, v12, v13
    s_waitcnt lgkmcnt(8)
    v_mfma_f32_32x32x16_bf16 a[48:63], v[34:37], v[82:85], a[48:63]
    ds_read_b64_tr_b16 v[34:35], v10 offset:1952
    ds_read_b64_tr_b16 v[36:37], v10 offset:2848
    v_fma_f32 v21, v21, v12, v13
    v_cvt_pk_bf16_f32 v86, v14, v15
    v_cvt_pk_bf16_f32 v87, v16, v17
    v_cvt_pk_bf16_f32 v88, v18, v19
    v_cvt_pk_bf16_f32 v89, v20, v21
    s_waitcnt lgkmcnt(8)
    v_mfma_f32_32x32x16_bf16 a[64:79], v[38:41], v[82:85], a[64:79]
    ds_read_b64_tr_b16 v[38:39], v10 offset:1984
    ds_read_b64_tr_b16 v[40:41], v10 offset:2880
    s_waitcnt vmcnt(13)
    s_barrier
    v_add_u32 v10, 103680, v8
    v_add_u32 v11, 103680, v9
    s_waitcnt lgkmcnt(8)
    v_mfma_f32_32x32x16_bf16 a[0:15], v[22:25], v[86:89], a[0:15]
    ds_read_b64_tr_b16 v[22:23], v10 offset:64
    ds_read_b64_tr_b16 v[24:25], v10 offset:960
    s_add_u32 m0, s36, 62208
    s_nop 0
    buffer_load_dwordx4 v5, s[24:27], s60 offen lds
    s_add_u32 s60, s60, s64
    v_lshlrev_b32 v14, 16, v90
    v_and_b32 v15, s68, v90
    v_lshlrev_b32 v16, 16, v91
    v_and_b32 v17, s68, v91
    v_lshlrev_b32 v18, 16, v92
    s_waitcnt lgkmcnt(8)
    v_mfma_f32_32x32x16_bf16 a[16:31], v[26:29], v[86:89], a[16:31]
    ds_read_b64_tr_b16 v[26:27], v10 offset:96
    ds_read_b64_tr_b16 v[28:29], v10 offset:992
    s_add_u32 m0, s37, 62208
    s_nop 0
    buffer_load_dwordx4 v6, s[28:31], s61 offen lds
    s_add_u32 s61, s61, s65
    v_and_b32 v19, s68, v92
    v_lshlrev_b32 v20, 16, v93
    v_and_b32 v21, s68, v93
    v_fma_f32 v14, v14, v12, v13
    v_fma_f32 v15, v15, v12, v13
    s_waitcnt lgkmcnt(8)
    v_mfma_f32_32x32x16_bf16 a[32:47], v[30:33], v[86:89], a[32:47]
    ds_read_b64_tr_b16 v[30:31], v10 offset:128
    ds_read_b64_tr_b16 v[32:33], v10 offset:1024
    s_add_u32 s57, s38, 62208
    s_cmp_eq_u32 s75, 1
    s_cselect_b32 m0, 153856, s57
    s_nop 0
    buffer_load_dwordx4 v7, s[32:35], s62 offen lds
    s_add_u32 s62, s62, s66
    v_fma_f32 v16, v16, v12, v13
    v_fma_f32 v17, v17, v12, v13
    v_fma_f32 v18, v18, v12, v13
    v_fma_f32 v19, v19, v12, v13
    v_fma_f32 v20, v20, v12, v13
    s_waitcnt lgkmcnt(8)
    v_mfma_f32_32x32x16_bf16 a[48:63], v[34:37], v[86:89], a[48:63]
    ds_read_b64_tr_b16 v[34:35], v10 offset:160
    ds_read_b64_tr_b16 v[36:37], v10 offset:1056
    v_fma_f32 v21, v21, v12, v13
    v_cvt_pk_bf16_f32 v90, v14, v15
    v_cvt_pk_bf16_f32 v91, v16, v17
    v_cvt_pk_bf16_f32 v92, v18, v19
    v_cvt_pk_bf16_f32 v93, v20, v21
    s_waitcnt lgkmcnt(8)
    v_mfma_f32_32x32x16_bf16 a[64:79], v[38:41], v[86:89], a[64:79]
    ds_read_b64_tr_b16 v[38:39], v10 offset:192
    ds_read_b64_tr_b16 v[40:41], v10 offset:1088
    s_waitcnt lgkmcnt(8)
    v_mfma_f32_32x32x16_bf16 a[0:15], v[22:25], v[90:93], a[0:15]
    ds_read_b64_tr_b16 v[22:23], v10 offset:1856
    ds_read_b64_tr_b16 v[24:25], v10 offset:2752
    v_lshlrev_b32 v14, 16, v94
    v_and_b32 v15, s68, v94
    v_lshlrev_b32 v16, 16, v95
    v_and_b32 v17, s68, v95
    v_lshlrev_b32 v18, 16, v96
    s_waitcnt lgkmcnt(8)
    v_mfma_f32_32x32x16_bf16 a[16:31], v[26:29], v[90:93], a[16:31]
    ds_read_b64_tr_b16 v[26:27], v10 offset:1888
    ds_read_b64_tr_b16 v[28:29], v10 offset:2784
    v_and_b32 v19, s68, v96
    v_lshlrev_b32 v20, 16, v97
    v_and_b32 v21, s68, v97
    v_fma_f32 v14, v14, v12, v13
    v_fma_f32 v15, v15, v12, v13
    s_waitcnt lgkmcnt(8)
    v_mfma_f32_32x32x16_bf16 a[32:47], v[30:33], v[90:93], a[32:47]
    ds_read_b64_tr_b16 v[30:31], v10 offset:1920
    ds_read_b64_tr_b16 v[32:33], v10 offset:2816
    v_fma_f32 v16, v16, v12, v13
    v_fma_f32 v17, v17, v12, v13
    v_fma_f32 v18, v18, v12, v13
    v_fma_f32 v19, v19, v12, v13
    v_fma_f32 v20, v20, v12, v13
    s_waitcnt lgkmcnt(8)
    v_mfma_f32_32x32x16_bf16 a[48:63], v[34:37], v[90:93], a[48:63]
    ds_read_b64_tr_b16 v[34:35], v10 offset:1952
    ds_read_b64_tr_b16 v[36:37], v10 offset:2848
    v_fma_f32 v21, v21, v12, v13
    v_cvt_pk_bf16_f32 v94, v14, v15
    v_cvt_pk_bf16_f32 v95, v16, v17
    v_cvt_pk_bf16_f32 v96, v18, v19
    v_cvt_pk_bf16_f32 v97, v20, v21
    s_waitcnt lgkmcnt(8)
    v_mfma_f32_32x32x16_bf16 a[64:79], v[38:41], v[90:93], a[64:79]
    ds_read_b64_tr_b16 v[38:39], v10 offset:1984
    ds_read_b64_tr_b16 v[40:41], v10 offset:2880
    s_waitcnt vmcnt(13)
    s_barrier
    v_add_u32 v10, 133120, v8
    v_add_u32 v11, 133120, v9
    s_waitcnt vmcnt(6)
    ds_read_b64_tr_b16 v[172:173], v171
    ds_read_b64_tr_b16 v[174:175], v171 offset:512
    s_waitcnt lgkmcnt(0)
    buffer_store_dwordx4 v[172:175], v2, s[12:15], s72 offen sc1
    s_waitcnt lgkmcnt(8)
    v_mfma_f32_32x32x16_bf16 a[0:15], v[22:25], v[94:97], a[0:15]
    ds_read_b64_tr_b16 v[22:23], v10 offset:64
    ds_read_b64_tr_b16 v[24:25], v10 offset:960
    s_add_u32 m0, s36, 82944
    s_nop 0
    buffer_load_dwordx4 v5, s[24:27], s60 offen lds
    s_add_u32 s60, s60, s64
    v_lshlrev_b32 v14, 16, v98
    v_and_b32 v15, s68, v98
    v_lshlrev_b32 v16, 16, v99
    v_and_b32 v17, s68, v99
    v_lshlrev_b32 v18, 16, v100
    s_waitcnt lgkmcnt(8)
    v_mfma_f32_32x32x16_bf16 a[16:31], v[26:29], v[94:97], a[16:31]
    ds_read_b64_tr_b16 v[26:27], v10 offset:96
    ds_read_b64_tr_b16 v[28:29], v10 offset:992
    s_add_u32 m0, s37, 82944
    s_nop 0
    buffer_load_dwordx4 v6, s[28:31], s61 offen lds
    s_add_u32 s61, s61, s65
    v_and_b32 v19, s68, v100
    v_lshlrev_b32 v20, 16, v101
    v_and_b32 v21, s68, v101
    v_fma_f32 v14, v14, v12, v13
    v_fma_f32 v15, v15, v12, v13
    s_waitcnt lgkmcnt(8)
    v_mfma_f32_32x32x16_bf16 a[32:47], v[30:33], v[94:97], a[32:47]
    ds_read_b64_tr_b16 v[30:31], v10 offset:128
    ds_read_b64_tr_b16 v[32:33], v10 offset:1024
    s_add_u32 s57, s38, 82944
    s_cmp_eq_u32 s75, 1
    s_cselect_b32 m0, 153856, s57
    s_nop 0
    buffer_load_dwordx4 v7, s[32:35], s62 offen lds
    s_add_u32 s62, s62, s66
    v_fma_f32 v16, v16, v12, v13
    v_fma_f32 v17, v17, v12, v13
    v_fma_f32 v18, v18, v12, v13
    v_fma_f32 v19, v19, v12, v13
    v_fma_f32 v20, v20, v12, v13
    s_waitcnt lgkmcnt(8)
    v_mfma_f32_32x32x16_bf16 a[48:63], v[34:37], v[94:97], a[48:63]
    ds_read_b64_tr_b16 v[34:35], v10 offset:160
    ds_read_b64_tr_b16 v[36:37], v10 offset:1056
    v_fma_f32 v21, v21, v12, v13
    v_cvt_pk_bf16_f32 v98, v14, v15
    v_cvt_pk_bf16_f32 v99, v16, v17
    v_cvt_pk_bf16_f32 v100, v18, v19
    v_cvt_pk_bf16_f32 v101, v20, v21
    s_waitcnt lgkmcnt(8)
    v_mfma_f32_32x32x16_bf16 a[64:79], v[38:41], v[94:97], a[64:79]
    ds_read_b64_tr_b16 v[38:39], v10 offset:192
    ds_read_b64_tr_b16 v[40:41], v10 offset:1088
    s_waitcnt lgkmcnt(8)
    v_mfma_f32_32x32x16_bf16 a[0:15], v[22:25], v[98:101], a[0:15]
    ds_read_b64_tr_b16 v[22:23], v10 offset:1856
    ds_read_b64_tr_b16 v[24:25], v10 offset:2752
    v_lshlrev_b32 v14, 16, v102
    v_and_b32 v15, s68, v102
    v_lshlrev_b32 v16, 16, v103
    v_and_b32 v17, s68, v103
    v_lshlrev_b32 v18, 16, v104
    s_waitcnt lgkmcnt(8)
    v_mfma_f32_32x32x16_bf16 a[16:31], v[26:29], v[98:101], a[16:31]
    ds_read_b64_tr_b16 v[26:27], v10 offset:1888
    ds_read_b64_tr_b16 v[28:29], v10 offset:2784
    v_and_b32 v19, s68, v104
    v_lshlrev_b32 v20, 16, v105
    v_and_b32 v21, s68, v105
    v_fma_f32 v14, v14, v12, v13
    v_fma_f32 v15, v15, v12, v13
    s_waitcnt lgkmcnt(8)
    v_mfma_f32_32x32x16_bf16 a[32:47], v[30:33], v[98:101], a[32:47]
    ds_read_b64_tr_b16 v[30:31], v10 offset:1920
    ds_read_b64_tr_b16 v[32:33], v10 offset:2816
    v_fma_f32 v16, v16, v12, v13
    v_fma_f32 v17, v17, v12, v13
    v_fma_f32 v18, v18, v12, v13
    v_fma_f32 v19, v19, v12, v13
    v_fma_f32 v20, v20, v12, v13
    s_waitcnt lgkmcnt(8)
    v_mfma_f32_32x32x16_bf16 a[48:63], v[34:37], v[98:101], a[48:63]
    ds_read_b64_tr_b16 v[34:35], v10 offset:1952
    ds_read_b64_tr_b16 v[36:37], v10 offset:2848
    v_fma_f32 v21, v21, v12, v13
    v_cvt_pk_bf16_f32 v102, v14, v15
    v_cvt_pk_bf16_f32 v103, v16, v17
    v_cvt_pk_bf16_f32 v104, v18, v19
    v_cvt_pk_bf16_f32 v105, v20, v21
    s_waitcnt lgkmcnt(8)
    v_mfma_f32_32x32x16_bf16 a[64:79], v[38:41], v[98:101], a[64:79]
    ds_read_b64_tr_b16 v[38:39], v10 offset:1984
    ds_read_b64_tr_b16 v[40:41], v10 offset:2880
    s_waitcnt vmcnt(14)
    s_barrier
    v_add_u32 v10, 0, v8
    v_add_u32 v11, 0, v9
    s_waitcnt lgkmcnt(8)
    v_mfma_f32_32x32x16_bf16 a[0:15], v[22:25], v[102:105], a[0:15]
    ds_read_b64_tr_b16 v[22:23], v10 offset:64
    ds_read_b64_tr_b16 v[24:25], v10 offset:960
    s_add_u32 m0, s36, 103680
    s_nop 0
    buffer_load_dwordx4 v5, s[24:27], s60 offen lds
    s_add_u32 s60, s60, s64
    v_lshlrev_b32 v14, 16, v106
    v_and_b32 v15, s68, v106
    v_lshlrev_b32 v16, 16, v107
    v_and_b32 v17, s68, v107
    v_lshlrev_b32 v18, 16, v108
    s_waitcnt lgkmcnt(8)
    v_mfma_f32_32x32x16_bf16 a[16:31], v[26:29], v[102:105], a[16:31]
    ds_read_b64_tr_b16 v[26:27], v10 offset:96
    ds_read_b64_tr_b16 v[28:29], v10 offset:992
    s_add_u32 m0, s37, 103680
    s_nop 0
    buffer_load_dwordx4 v6, s[28:31], s61 offen lds
    s_add_u32 s61, s61, s65
    v_and_b32 v19, s68, v108
    v_lshlrev_b32 v20, 16, v109
    v_and_b32 v21, s68, v109
    v_fma_f32 v14, v14, v12, v13
    v_fma_f32 v15, v15, v12, v13
    s_waitcnt lgkmcnt(8)
    v_mfma_f32_32x32x16_bf16 a[32:47], v[30:33], v[102:105], a[32:47]
    ds_read_b64_tr_b16 v[30:31], v10 offset:128
    ds_read_b64_tr_b16 v[32:33], v10 offset:1024
    s_add_u32 s57, s38, 103680
    s_cmp_eq_u32 s75, 1
    s_cselect_b32 m0, 153856, s57
    s_nop 0
    buffer_load_dwordx4 v7, s[32:35], s62 offen lds
    s_add_u32 s62, s62, s66
    v_fma_f32 v16, v16, v12, v13
    v_fma_f32 v17, v17, v12, v13
    v_fma_f32 v18, v18, v12, v13
    v_fma_f32 v19, v19, v12, v13
    v_fma_f32 v20, v20, v12, v13
    s_waitcnt lgkmcnt(8)
    v_mfma_f32_32x32x16_bf16 a[48:63], v[34:37], v[102:105], a[48:63]
    ds_read_b64_tr_b16 v[34:35], v10 offset:160
    ds_read_b64_tr_b16 v[36:37], v10 offset:1056
    v_fma_f32 v21, v21, v12, v13
    v_cvt_pk_bf16_f32 v106, v14, v15
    v_cvt_pk_bf16_f32 v107, v16, v17
    v_cvt_pk_bf16_f32 v108, v18, v19
    v_cvt_pk_bf16_f32 v109, v20, v21
    s_waitcnt lgkmcnt(8)
    v_mfma_f32_32x32x16_bf16 a[64:79], v[38:41], v[102:105], a[64:79]
    ds_read_b64_tr_b16 v[38:39], v10 offset:192
    ds_read_b64_tr_b16 v[40:41], v10 offset:1088
    s_add_u32 s55, s73, 2048
    s_lshr_b32 s56, s55, 4
    s_and_b32 s55, s55, 15
    s_mul_i32 s72, s55, 144
    s_add_u32 s72, s72, s56
    s_lshl_b32 s72, s72, 10
    s_add_u32 s72, s72, 10485760
    s_mov_b32 s18, 524288
    s_cmp_lt_u32 s56, 112
    s_cselect_b32 s16, s50, s48
    s_cselect_b32 s17, s51, s49
    s_cselect_b32 s18, 1835008, s18
    s_cselect_b32 s54, 0, 112
    s_and_b32 s17, s17, 0xffff
    s_mov_b32 s19, 0x00020000
    s_sub_u32 s56, s56, s54
    s_lshl_b32 s56, s56, 14
    s_mov_b32 m0, s74
    s_lshl_b32 s55, s55, 6
    s_add_u32 s56, s56, s55
    buffer_load_dwordx4 v170, s[16:19], s56 offen lds
    s_waitcnt lgkmcnt(8)
    v_mfma_f32_32x32x16_bf16 a[0:15], v[22:25], v[106:109], a[0:15]
    ds_read_b64_tr_b16 v[22:23], v10 offset:1856
    ds_read_b64_tr_b16 v[24:25], v10 offset:2752
    v_lshlrev_b32 v14, 16, v110
    v_and_b32 v15, s68, v110
    v_lshlrev_b32 v16, 16, v111
    v_and_b32 v17, s68, v111
    v_lshlrev_b32 v18, 16, v112
    s_waitcnt lgkmcnt(8)
    v_mfma_f32_32x32x16_bf16 a[16:31], v[26:29], v[106:109], a[16:31]
    ds_read_b64_tr_b16 v[26:27], v10 offset:1888
    ds_read_b64_tr_b16 v[28:29], v10 offset:2784
    v_and_b32 v19, s68, v112
    v_lshlrev_b32 v20, 16, v113
    v_and_b32 v21, s68, v113
    v_fma_f32 v14, v14, v12, v13
    v_fma_f32 v15, v15, v12, v13
    s_waitcnt lgkmcnt(8)
    v_mfma_f32_32x32x16_bf16 a[32:47], v[30:33], v[106:109], a[32:47]
    ds_read_b64_tr_b16 v[30:31], v10 offset:1920
    ds_read_b64_tr_b16 v[32:33], v10 offset:2816
    v_fma_f32 v16, v16, v12, v13
    v_fma_f32 v17, v17, v12, v13
    v_fma_f32 v18, v18, v12, v13
    v_fma_f32 v19, v19, v12, v13
    v_fma_f32 v20, v20, v12, v13
    s_waitcnt lgkmcnt(8)
    v_mfma_f32_32x32x16_bf16 a[48:63], v[34:37], v[106:109], a[48:63]
    ds_read_b64_tr_b16 v[34:35], v10 offset:1952
    ds_read_b64_tr_b16 v[36:37], v10 offset:2848
    v_fma_f32 v21, v21, v12, v13
    v_cvt_pk_bf16_f32 v110, v14, v15
    v_cvt_pk_bf16_f32 v111, v16, v17
    v_cvt_pk_bf16_f32 v112, v18, v19
    v_cvt_pk_bf16_f32 v113, v20, v21
    s_waitcnt lgkmcnt(8)
    v_mfma_f32_32x32x16_bf16 a[64:79], v[38:41], v[106:109], a[64:79]
    ds_read_b64_tr_b16 v[38:39], v10 offset:1984
    ds_read_b64_tr_b16 v[40:41], v10 offset:2880
    s_waitcnt vmcnt(15)
    s_barrier
    v_add_u32 v10, 20736, v8
    v_add_u32 v11, 20736, v9
    s_waitcnt lgkmcnt(8)
    v_mfma_f32_32x32x16_bf16 a[0:15], v[22:25], v[110:113], a[0:15]
    ds_read_b64_tr_b16 v[22:23], v10 offset:64
    ds_read_b64_tr_b16 v[24:25], v10 offset:960
    s_add_u32 m0, s36, 133120
    s_nop 0
    buffer_load_dwordx4 v5, s[24:27], s60 offen lds
    s_add_u32 s60, s60, s64
    v_lshlrev_b32 v14, 16, v114
    v_and_b32 v15, s68, v114
    v_lshlrev_b32 v16, 16, v115
    v_and_b32 v17, s68, v115
    v_lshlrev_b32 v18, 16, v116
    s_waitcnt lgkmcnt(8)
    v_mfma_f32_32x32x16_bf16 a[16:31], v[26:29], v[110:113], a[16:31]
    ds_read_b64_tr_b16 v[26:27], v10 offset:96
    ds_read_b64_tr_b16 v[28:29], v10 offset:992
    s_add_u32 m0, s37, 133120
    s_nop 0
    buffer_load_dwordx4 v6, s[28:31], s61 offen lds
    s_add_u32 s61, s61, s65
    v_and_b32 v19, s68, v116
    v_lshlrev_b32 v20, 16, v117
    v_and_b32 v21, s68, v117
    v_fma_f32 v14, v14, v12, v13
    v_fma_f32 v15, v15, v12, v13
    s_waitcnt lgkmcnt(8)
    v_mfma_f32_32x32x16_bf16 a[32:47], v[30:33], v[110:113], a[32:47]
    ds_read_b64_tr_b16 v[30:31], v10 offset:128
    ds_read_b64_tr_b16 v[32:33], v10 offset:1024
    s_add_u32 s57, s38, 133120
    s_cmp_eq_u32 s75, 1
    s_cselect_b32 m0, 153856, s57
    s_nop 0
    buffer_load_dwordx4 v7, s[32:35], s62 offen lds
    s_add_u32 s62, s62, s66
    v_fma_f32 v16, v16, v12, v13
    v_fma_f32 v17, v17, v12, v13
    v_fma_f32 v18, v18, v12, v13
    v_fma_f32 v19, v19, v12, v13
    v_fma_f32 v20, v20, v12, v13
    s_waitcnt lgkmcnt(8)
    v_mfma_f32_32x32x16_bf16 a[48:63], v[34:37], v[110:113], a[48:63]
    ds_read_b64_tr_b16 v[34:35], v10 offset:160
    ds_read_b64_tr_b16 v[36:37], v10 offset:1056
    v_fma_f32 v21, v21, v12, v13
    v_cvt_pk_bf16_f32 v114, v14, v15
    v_cvt_pk_bf16_f32 v115, v16, v17
    v_cvt_pk_bf16_f32 v116, v18, v19
    v_cvt_pk_bf16_f32 v117, v20, v21
    s_waitcnt lgkmcnt(8)
    v_mfma_f32_32x32x16_bf16 a[64:79], v[38:41], v[110:113], a[64:79]
    ds_read_b64_tr_b16 v[38:39], v10 offset:192
    ds_read_b64_tr_b16 v[40:41], v10 offset:1088
    s_waitcnt lgkmcnt(8)
    v_mfma_f32_32x32x16_bf16 a[0:15], v[22:25], v[114:117], a[0:15]
    ds_read_b64_tr_b16 v[22:23], v10 offset:1856
    ds_read_b64_tr_b16 v[24:25], v10 offset:2752
    v_lshlrev_b32 v14, 16, v118
    v_and_b32 v15, s68, v118
    v_lshlrev_b32 v16, 16, v119
    v_and_b32 v17, s68, v119
    v_lshlrev_b32 v18, 16, v120
    s_waitcnt lgkmcnt(8)
    v_mfma_f32_32x32x16_bf16 a[16:31], v[26:29], v[114:117], a[16:31]
    ds_read_b64_tr_b16 v[26:27], v10 offset:1888
    ds_read_b64_tr_b16 v[28:29], v10 offset:2784
    v_and_b32 v19, s68, v120
    v_lshlrev_b32 v20, 16, v121
    v_and_b32 v21, s68, v121
    v_fma_f32 v14, v14, v12, v13
    v_fma_f32 v15, v15, v12, v13
    s_waitcnt lgkmcnt(8)
    v_mfma_f32_32x32x16_bf16 a[32:47], v[30:33], v[114:117], a[32:47]
    ds_read_b64_tr_b16 v[30:31], v10 offset:1920
    ds_read_b64_tr_b16 v[32:33], v10 offset:2816
    v_fma_f32 v16, v16, v12, v13
    v_fma_f32 v17, v17, v12, v13
    v_fma_f32 v18, v18, v12, v13
    v_fma_f32 v19, v19, v12, v13
    v_fma_f32 v20, v20, v12, v13
    s_waitcnt lgkmcnt(8)
    v_mfma_f32_32x32x16_bf16 a[48:63], v[34:37], v[114:117], a[48:63]
    ds_read_b64_tr_b16 v[34:35], v10 offset:1952
    ds_read_b64_tr_b16 v[36:37], v10 offset:2848
    v_fma_f32 v21, v21, v12, v13
    v_cvt_pk_bf16_f32 v118, v14, v15
    v_cvt_pk_bf16_f32 v119, v16, v17
    v_cvt_pk_bf16_f32 v120, v18, v19
    v_cvt_pk_bf16_f32 v121, v20, v21
    s_waitcnt lgkmcnt(8)
    v_mfma_f32_32x32x16_bf16 a[64:79], v[38:41], v[114:117], a[64:79]
    ds_read_b64_tr_b16 v[38:39], v10 offset:1984
    ds_read_b64_tr_b16 v[40:41], v10 offset:2880
    s_waitcnt vmcnt(14)
    s_barrier
    v_add_u32 v10, 41472, v8
    v_add_u32 v11, 41472, v9
    s_waitcnt lgkmcnt(8)
    v_mfma_f32_32x32x16_bf16 a[0:15], v[22:25], v[118:121], a[0:15]
    ds_read_b64_tr_b16 v[22:23], v10 offset:64
    ds_read_b64_tr_b16 v[24:25], v10 offset:960
    s_add_u32 m0, s36, 0
    s_nop 0
    buffer_load_dwordx4 v5, s[24:27], s60 offen lds
    s_add_u32 s60, s60, s64
    v_lshlrev_b32 v14, 16, v122
    v_and_b32 v15, s68, v122
    v_lshlrev_b32 v16, 16, v123
    v_and_b32 v17, s68, v123
    v_lshlrev_b32 v18, 16, v124
    s_waitcnt lgkmcnt(8)
    v_mfma_f32_32x32x16_bf16 a[16:31], v[26:29], v[118:121], a[16:31]
    ds_read_b64_tr_b16 v[26:27], v10 offset:96
    ds_read_b64_tr_b16 v[28:29], v10 offset:992
    s_add_u32 m0, s37, 0
    s_nop 0
    buffer_load_dwordx4 v6, s[28:31], s61 offen lds
    s_add_u32 s61, s61, s65
    v_and_b32 v19, s68, v124
    v_lshlrev_b32 v20, 16, v125
    v_and_b32 v21, s68, v125
    v_fma_f32 v14, v14, v12, v13
    v_fma_f32 v15, v15, v12, v13
    s_waitcnt lgkmcnt(8)
    v_mfma_f32_32x32x16_bf16 a[32:47], v[30:33], v[118:121], a[32:47]
    ds_read_b64_tr_b16 v[30:31], v10 offset:128
    ds_read_b64_tr_b16 v[32:33], v10 offset:1024
    s_add_u32 s57, s38, 0
    s_cmp_eq_u32 s75, 1
    s_cselect_b32 m0, 153856, s57
    s_nop 0
    buffer_load_dwordx4 v7, s[32:35], s62 offen lds
    s_add_u32 s62, s62, s66
    v_fma_f32 v16, v16, v12, v13
    v_fma_f32 v17, v17, v12, v13
    v_fma_f32 v18, v18, v12, v13
    v_fma_f32 v19, v19, v12, v13
    v_fma_f32 v20, v20, v12, v13
    s_waitcnt lgkmcnt(8)
    v_mfma_f32_32x32x16_bf16 a[48:63], v[34:37], v[118:121], a[48:63]
    ds_read_b64_tr_b16 v[34:35], v10 offset:160
    ds_read_b64_tr_b16 v[36:37], v10 offset:1056
    v_fma_f32 v21, v21, v12, v13
    v_cvt_pk_bf16_f32 v122, v14, v15
    v_cvt_pk_bf16_f32 v123, v16, v17
    v_cvt_pk_bf16_f32 v124, v18, v19
    v_cvt_pk_bf16_f32 v125, v20, v21
    s_waitcnt lgkmcnt(8)
    v_mfma_f32_32x32x16_bf16 a[64:79], v[38:41], v[118:121], a[64:79]
    ds_read_b64_tr_b16 v[38:39], v10 offset:192
    ds_read_b64_tr_b16 v[40:41], v10 offset:1088
    s_waitcnt lgkmcnt(8)
    v_mfma_f32_32x32x16_bf16 a[0:15], v[22:25], v[122:125], a[0:15]
    ds_read_b64_tr_b16 v[22:23], v10 offset:1856
    ds_read_b64_tr_b16 v[24:25], v10 offset:2752
    v_lshlrev_b32 v14, 16, v126
    v_and_b32 v15, s68, v126
    v_lshlrev_b32 v16, 16, v127
    v_and_b32 v17, s68, v127
    v_lshlrev_b32 v18, 16, v128
    s_waitcnt lgkmcnt(8)
    v_mfma_f32_32x32x16_bf16 a[16:31], v[26:29], v[122:125], a[16:31]
    ds_read_b64_tr_b16 v[26:27], v10 offset:1888
    ds_read_b64_tr_b16 v[28:29], v10 offset:2784
    v_and_b32 v19, s68, v128
    v_lshlrev_b32 v20, 16, v129
    v_and_b32 v21, s68, v129
    v_fma_f32 v14, v14, v12, v13
    v_fma_f32 v15, v15, v12, v13
    s_waitcnt lgkmcnt(8)
    v_mfma_f32_32x32x16_bf16 a[32:47], v[30:33], v[122:125], a[32:47]
    ds_read_b64_tr_b16 v[30:31], v10 offset:1920
    ds_read_b64_tr_b16 v[32:33], v10 offset:2816
    v_fma_f32 v16, v16, v12, v13
    v_fma_f32 v17, v17, v12, v13
    v_fma_f32 v18, v18, v12, v13
    v_fma_f32 v19, v19, v12, v13
    v_fma_f32 v20, v20, v12, v13
    s_waitcnt lgkmcnt(8)
    v_mfma_f32_32x32x16_bf16 a[48:63], v[34:37], v[122:125], a[48:63]
    ds_read_b64_tr_b16 v[34:35], v10 offset:1952
    ds_read_b64_tr_b16 v[36:37], v10 offset:2848
    v_fma_f32 v21, v21, v12, v13
    v_cvt_pk_bf16_f32 v126, v14, v15
    v_cvt_pk_bf16_f32 v127, v16, v17
    v_cvt_pk_bf16_f32 v128, v18, v19
    v_cvt_pk_bf16_f32 v129, v20, v21
    s_waitcnt lgkmcnt(8)
    v_mfma_f32_32x32x16_bf16 a[64:79], v[38:41], v[122:125], a[64:79]
    ds_read_b64_tr_b16 v[38:39], v10 offset:1984
    ds_read_b64_tr_b16 v[40:41], v10 offset:2880
    s_waitcnt vmcnt(14)
    s_barrier
    v_add_u32 v10, 62208, v8
    v_add_u32 v11, 62208, v9
    s_waitcnt vmcnt(6)
    ds_read_b64_tr_b16 v[172:173], v171
    ds_read_b64_tr_b16 v[174:175], v171 offset:512
    s_waitcnt lgkmcnt(0)
    buffer_store_dwordx4 v[172:175], v2, s[20:23], s72 offen sc1
    s_waitcnt lgkmcnt(8)
    v_mfma_f32_32x32x16_bf16 a[0:15], v[22:25], v[126:129], a[0:15]
    ds_read_b64_tr_b16 v[22:23], v10 offset:64
    ds_read_b64_tr_b16 v[24:25], v10 offset:960
    v_lshlrev_b32 v14, 16, v130
    v_and_b32 v15, s68, v130
    v_lshlrev_b32 v16, 16, v131
    v_and_b32 v17, s68, v131
    v_lshlrev_b32 v18, 16, v132
    s_waitcnt lgkmcnt(8)
    v_mfma_f32_32x32x16_bf16 a[16:31], v[26:29], v[126:129], a[16:31]
    ds_read_b64_tr_b16 v[26:27], v10 offset:96
    ds_read_b64_tr_b16 v[28:29], v10 offset:992
    v_and_b32 v19, s68, v132
    v_lshlrev_b32 v20, 16, v133
    v_and_b32 v21, s68, v133
    v_fma_f32 v14, v14, v12, v13
    v_fma_f32 v15, v15, v12, v13
    s_waitcnt lgkmcnt(8)
    v_mfma_f32_32x32x16_bf16 a[32:47], v[30:33], v[126:129], a[32:47]
    ds_read_b64_tr_b16 v[30:31], v10 offset:128
    ds_read_b64_tr_b16 v[32:33], v10 offset:1024
    v_fma_f32 v16, v16, v12, v13
    v_fma_f32 v17, v17, v12, v13
    v_fma_f32 v18, v18, v12, v13
    v_fma_f32 v19, v19, v12, v13
    v_fma_f32 v20, v20, v12, v13
    s_waitcnt lgkmcnt(8)
    v_mfma_f32_32x32x16_bf16 a[48:63], v[34:37], v[126:129], a[48:63]
    ds_read_b64_tr_b16 v[34:35], v10 offset:160
    ds_read_b64_tr_b16 v[36:37], v10 offset:1056
    v_fma_f32 v21, v21, v12, v13
    v_cvt_pk_bf16_f32 v130, v14, v15
    v_cvt_pk_bf16_f32 v131, v16, v17
    v_cvt_pk_bf16_f32 v132, v18, v19
    v_cvt_pk_bf16_f32 v133, v20, v21
    s_waitcnt lgkmcnt(8)
    v_mfma_f32_32x32x16_bf16 a[64:79], v[38:41], v[126:129], a[64:79]
    ds_read_b64_tr_b16 v[38:39], v10 offset:192
    ds_read_b64_tr_b16 v[40:41], v10 offset:1088
    s_waitcnt lgkmcnt(8)
    v_mfma_f32_32x32x16_bf16 a[0:15], v[22:25], v[130:133], a[0:15]
    ds_read_b64_tr_b16 v[22:23], v10 offset:1856
    ds_read_b64_tr_b16 v[24:25], v10 offset:2752
    v_lshlrev_b32 v14, 16, v134
    v_and_b32 v15, s68, v134
    v_lshlrev_b32 v16, 16, v135
    v_and_b32 v17, s68, v135
    v_lshlrev_b32 v18, 16, v136
    s_waitcnt lgkmcnt(8)
    v_mfma_f32_32x32x16_bf16 a[16:31], v[26:29], v[130:133], a[16:31]
    ds_read_b64_tr_b16 v[26:27], v10 offset:1888
    ds_read_b64_tr_b16 v[28:29], v10 offset:2784
    v_and_b32 v19, s68, v136
    v_lshlrev_b32 v20, 16, v137
    v_and_b32 v21, s68, v137
    v_fma_f32 v14, v14, v12, v13
    v_fma_f32 v15, v15, v12, v13
    s_waitcnt lgkmcnt(8)
    v_mfma_f32_32x32x16_bf16 a[32:47], v[30:33], v[130:133], a[32:47]
    ds_read_b64_tr_b16 v[30:31], v10 offset:1920
    ds_read_b64_tr_b16 v[32:33], v10 offset:2816
    v_fma_f32 v16, v16, v12, v13
    v_fma_f32 v17, v17, v12, v13
    v_fma_f32 v18, v18, v12, v13
    v_fma_f32 v19, v19, v12, v13
    v_fma_f32 v20, v20, v12, v13
    s_waitcnt lgkmcnt(8)
    v_mfma_f32_32x32x16_bf16 a[48:63], v[34:37], v[130:133], a[48:63]
    ds_read_b64_tr_b16 v[34:35], v10 offset:1952
    ds_read_b64_tr_b16 v[36:37], v10 offset:2848
    v_fma_f32 v21, v21, v12, v13
    v_cvt_pk_bf16_f32 v134, v14, v15
    v_cvt_pk_bf16_f32 v135, v16, v17
    v_cvt_pk_bf16_f32 v136, v18, v19
    v_cvt_pk_bf16_f32 v137, v20, v21
    s_waitcnt lgkmcnt(8)
    v_mfma_f32_32x32x16_bf16 a[64:79], v[38:41], v[130:133], a[64:79]
    ds_read_b64_tr_b16 v[38:39], v10 offset:1984
    ds_read_b64_tr_b16 v[40:41], v10 offset:2880
    s_waitcnt vmcnt(11)
    s_barrier
    v_add_u32 v10, 82944, v8
    v_add_u32 v11, 82944, v9
    s_waitcnt lgkmcnt(8)
    v_mfma_f32_32x32x16_bf16 a[0:15], v[22:25], v[134:137], a[0:15]
    ds_read_b64_tr_b16 v[22:23], v10 offset:64
    ds_read_b64_tr_b16 v[24:25], v10 offset:960
    v_lshlrev_b32 v14, 16, v138
    v_and_b32 v15, s68, v138
    v_lshlrev_b32 v16, 16, v139
    v_and_b32 v17, s68, v139
    v_lshlrev_b32 v18, 16, v140
    s_waitcnt lgkmcnt(8)
    v_mfma_f32_32x32x16_bf16 a[16:31], v[26:29], v[134:137], a[16:31]
    ds_read_b64_tr_b16 v[26:27], v10 offset:96
    ds_read_b64_tr_b16 v[28:29], v10 offset:992
    v_and_b32 v19, s68, v140
    v_lshlrev_b32 v20, 16, v141
    v_and_b32 v21, s68, v141
    v_fma_f32 v14, v14, v12, v13
    v_fma_f32 v15, v15, v12, v13
    s_waitcnt lgkmcnt(8)
    v_mfma_f32_32x32x16_bf16 a[32:47], v[30:33], v[134:137], a[32:47]
    ds_read_b64_tr_b16 v[30:31], v10 offset:128
    ds_read_b64_tr_b16 v[32:33], v10 offset:1024
    v_fma_f32 v16, v16, v12, v13
    v_fma_f32 v17, v17, v12, v13
    v_fma_f32 v18, v18, v12, v13
    v_fma_f32 v19, v19, v12, v13
    v_fma_f32 v20, v20, v12, v13
    s_waitcnt lgkmcnt(8)
    v_mfma_f32_32x32x16_bf16 a[48:63], v[34:37], v[134:137], a[48:63]
    ds_read_b64_tr_b16 v[34:35], v10 offset:160
    ds_read_b64_tr_b16 v[36:37], v10 offset:1056
    v_fma_f32 v21, v21, v12, v13
    v_cvt_pk_bf16_f32 v138, v14, v15
    v_cvt_pk_bf16_f32 v139, v16, v17
    v_cvt_pk_bf16_f32 v140, v18, v19
    v_cvt_pk_bf16_f32 v141, v20, v21
    s_waitcnt lgkmcnt(8)
    v_mfma_f32_32x32x16_bf16 a[64:79], v[38:41], v[134:137], a[64:79]
    ds_read_b64_tr_b16 v[38:39], v10 offset:192
    ds_read_b64_tr_b16 v[40:41], v10 offset:1088
    s_waitcnt lgkmcnt(8)
    v_mfma_f32_32x32x16_bf16 a[0:15], v[22:25], v[138:141], a[0:15]
    ds_read_b64_tr_b16 v[22:23], v10 offset:1856
    ds_read_b64_tr_b16 v[24:25], v10 offset:2752
    v_lshlrev_b32 v14, 16, v142
    v_and_b32 v15, s68, v142
    v_lshlrev_b32 v16, 16, v143
    v_and_b32 v17, s68, v143
    v_lshlrev_b32 v18, 16, v144
    s_waitcnt lgkmcnt(8)
    v_mfma_f32_32x32x16_bf16 a[16:31], v[26:29], v[138:141], a[16:31]
    ds_read_b64_tr_b16 v[26:27], v10 offset:1888
    ds_read_b64_tr_b16 v[28:29], v10 offset:2784
    v_and_b32 v19, s68, v144
    v_lshlrev_b32 v20, 16, v145
    v_and_b32 v21, s68, v145
    v_fma_f32 v14, v14, v12, v13
    v_fma_f32 v15, v15, v12, v13
    s_waitcnt lgkmcnt(8)
    v_mfma_f32_32x32x16_bf16 a[32:47], v[30:33], v[138:141], a[32:47]
    ds_read_b64_tr_b16 v[30:31], v10 offset:1920
    ds_read_b64_tr_b16 v[32:33], v10 offset:2816
    v_fma_f32 v16, v16, v12, v13
    v_fma_f32 v17, v17, v12, v13
    v_fma_f32 v18, v18, v12, v13
    v_fma_f32 v19, v19, v12, v13
    v_fma_f32 v20, v20, v12, v13
    s_waitcnt lgkmcnt(8)
    v_mfma_f32_32x32x16_bf16 a[48:63], v[34:37], v[138:141], a[48:63]
    ds_read_b64_tr_b16 v[34:35], v10 offset:1952
    ds_read_b64_tr_b16 v[36:37], v10 offset:2848
    v_fma_f32 v21, v21, v12, v13
    v_cvt_pk_bf16_f32 v142, v14, v15
    v_cvt_pk_bf16_f32 v143, v16, v17
    v_cvt_pk_bf16_f32 v144, v18, v19
    v_cvt_pk_bf16_f32 v145, v20, v21
    s_waitcnt lgkmcnt(8)
    v_mfma_f32_32x32x16_bf16 a[64:79], v[38:41], v[138:141], a[64:79]
    ds_read_b64_tr_b16 v[38:39], v10 offset:1984
    ds_read_b64_tr_b16 v[40:41], v10 offset:2880
    s_waitcnt vmcnt(8)
    s_barrier
    v_add_u32 v10, 103680, v8
    v_add_u32 v11, 103680, v9
    s_waitcnt lgkmcnt(8)
    v_mfma_f32_32x32x16_bf16 a[0:15], v[22:25], v[142:145], a[0:15]
    ds_read_b64_tr_b16 v[22:23], v10 offset:64
    ds_read_b64_tr_b16 v[24:25], v10 offset:960
    v_lshlrev_b32 v14, 16, v146
    v_and_b32 v15, s68, v146
    v_lshlrev_b32 v16, 16, v147
    v_and_b32 v17, s68, v147
    v_lshlrev_b32 v18, 16, v148
    s_waitcnt lgkmcnt(8)
    v_mfma_f32_32x32x16_bf16 a[16:31], v[26:29], v[142:145], a[16:31]
    ds_read_b64_tr_b16 v[26:27], v10 offset:96
    ds_read_b64_tr_b16 v[28:29], v10 offset:992
    v_and_b32 v19, s68, v148
    v_lshlrev_b32 v20, 16, v149
    v_and_b32 v21, s68, v149
    v_fma_f32 v14, v14, v12, v13
    v_fma_f32 v15, v15, v12, v13
    s_waitcnt lgkmcnt(8)
    v_mfma_f32_32x32x16_bf16 a[32:47], v[30:33], v[142:145], a[32:47]
    ds_read_b64_tr_b16 v[30:31], v10 offset:128
    ds_read_b64_tr_b16 v[32:33], v10 offset:1024
    v_fma_f32 v16, v16, v12, v13
    v_fma_f32 v17, v17, v12, v13
    v_fma_f32 v18, v18, v12, v13
    v_fma_f32 v19, v19, v12, v13
    v_fma_f32 v20, v20, v12, v13
    s_waitcnt lgkmcnt(8)
    v_mfma_f32_32x32x16_bf16 a[48:63], v[34:37], v[142:145], a[48:63]
    ds_read_b64_tr_b16 v[34:35], v10 offset:160
    ds_read_b64_tr_b16 v[36:37], v10 offset:1056
    v_fma_f32 v21, v21, v12, v13
    v_cvt_pk_bf16_f32 v146, v14, v15
    v_cvt_pk_bf16_f32 v147, v16, v17
    v_cvt_pk_bf16_f32 v148, v18, v19
    v_cvt_pk_bf16_f32 v149, v20, v21
    s_waitcnt lgkmcnt(8)
    v_mfma_f32_32x32x16_bf16 a[64:79], v[38:41], v[142:145], a[64:79]
    ds_read_b64_tr_b16 v[38:39], v10 offset:192
    ds_read_b64_tr_b16 v[40:41], v10 offset:1088
    s_waitcnt lgkmcnt(8)
    v_mfma_f32_32x32x16_bf16 a[0:15], v[22:25], v[146:149], a[0:15]
    ds_read_b64_tr_b16 v[22:23], v10 offset:1856
    ds_read_b64_tr_b16 v[24:25], v10 offset:2752
    v_lshlrev_b32 v14, 16, v150
    v_and_b32 v15, s68, v150
    v_lshlrev_b32 v16, 16, v151
    v_and_b32 v17, s68, v151
    v_lshlrev_b32 v18, 16, v152
    s_waitcnt lgkmcnt(8)
    v_mfma_f32_32x32x16_bf16 a[16:31], v[26:29], v[146:149], a[16:31]
    ds_read_b64_tr_b16 v[26:27], v10 offset:1888
    ds_read_b64_tr_b16 v[28:29], v10 offset:2784
    v_and_b32 v19, s68, v152
    v_lshlrev_b32 v20, 16, v153
    v_and_b32 v21, s68, v153
    v_fma_f32 v14, v14, v12, v13
    v_fma_f32 v15, v15, v12, v13
    s_waitcnt lgkmcnt(8)
    v_mfma_f32_32x32x16_bf16 a[32:47], v[30:33], v[146:149], a[32:47]
    ds_read_b64_tr_b16 v[30:31], v10 offset:1920
    ds_read_b64_tr_b16 v[32:33], v10 offset:2816
    v_fma_f32 v16, v16, v12, v13
    v_fma_f32 v17, v17, v12, v13
    v_fma_f32 v18, v18, v12, v13
    v_fma_f32 v19, v19, v12, v13
    v_fma_f32 v20, v20, v12, v13
    s_waitcnt lgkmcnt(8)
    v_mfma_f32_32x32x16_bf16 a[48:63], v[34:37], v[146:149], a[48:63]
    ds_read_b64_tr_b16 v[34:35], v10 offset:1952
    ds_read_b64_tr_b16 v[36:37], v10 offset:2848
    v_fma_f32 v21, v21, v12, v13
    v_cvt_pk_bf16_f32 v150, v14, v15
    v_cvt_pk_bf16_f32 v151, v16, v17
    v_cvt_pk_bf16_f32 v152, v18, v19
    v_cvt_pk_bf16_f32 v153, v20, v21
    s_waitcnt lgkmcnt(8)
    v_mfma_f32_32x32x16_bf16 a[64:79], v[38:41], v[146:149], a[64:79]
    ds_read_b64_tr_b16 v[38:39], v10 offset:1984
    ds_read_b64_tr_b16 v[40:41], v10 offset:2880
    s_waitcnt vmcnt(4)
    s_barrier
    v_add_u32 v10, 133120, v8
    v_add_u32 v11, 133120, v9
    s_waitcnt lgkmcnt(8)
    v_mfma_f32_32x32x16_bf16 a[0:15], v[22:25], v[150:153], a[0:15]
    ds_read_b64_tr_b16 v[22:23], v10 offset:64
    ds_read_b64_tr_b16 v[24:25], v10 offset:960
    v_lshlrev_b32 v14, 16, v154
    v_and_b32 v15, s68, v154
    v_lshlrev_b32 v16, 16, v155
    v_and_b32 v17, s68, v155
    v_lshlrev_b32 v18, 16, v156
    s_waitcnt lgkmcnt(8)
    v_mfma_f32_32x32x16_bf16 a[16:31], v[26:29], v[150:153], a[16:31]
    ds_read_b64_tr_b16 v[26:27], v10 offset:96
    ds_read_b64_tr_b16 v[28:29], v10 offset:992
    v_and_b32 v19, s68, v156
    v_lshlrev_b32 v20, 16, v157
    v_and_b32 v21, s68, v157
    v_fma_f32 v14, v14, v12, v13
    v_fma_f32 v15, v15, v12, v13
    s_waitcnt lgkmcnt(8)
    v_mfma_f32_32x32x16_bf16 a[32:47], v[30:33], v[150:153], a[32:47]
    ds_read_b64_tr_b16 v[30:31], v10 offset:128
    ds_read_b64_tr_b16 v[32:33], v10 offset:1024
    v_fma_f32 v16, v16, v12, v13
    v_fma_f32 v17, v17, v12, v13
    v_fma_f32 v18, v18, v12, v13
    v_fma_f32 v19, v19, v12, v13
    v_fma_f32 v20, v20, v12, v13
    s_waitcnt lgkmcnt(8)
    v_mfma_f32_32x32x16_bf16 a[48:63], v[34:37], v[150:153], a[48:63]
    ds_read_b64_tr_b16 v[34:35], v10 offset:160
    ds_read_b64_tr_b16 v[36:37], v10 offset:1056
    v_fma_f32 v21, v21, v12, v13
    v_cvt_pk_bf16_f32 v154, v14, v15
    v_cvt_pk_bf16_f32 v155, v16, v17
    v_cvt_pk_bf16_f32 v156, v18, v19
    v_cvt_pk_bf16_f32 v157, v20, v21
    s_waitcnt lgkmcnt(8)
    v_mfma_f32_32x32x16_bf16 a[64:79], v[38:41], v[150:153], a[64:79]
    ds_read_b64_tr_b16 v[38:39], v10 offset:192
    ds_read_b64_tr_b16 v[40:41], v10 offset:1088
    s_waitcnt lgkmcnt(8)
    v_mfma_f32_32x32x16_bf16 a[0:15], v[22:25], v[154:157], a[0:15]
    ds_read_b64_tr_b16 v[22:23], v10 offset:1856
    ds_read_b64_tr_b16 v[24:25], v10 offset:2752
    v_lshlrev_b32 v14, 16, v158
    v_and_b32 v15, s68, v158
    v_lshlrev_b32 v16, 16, v159
    v_and_b32 v17, s68, v159
    v_lshlrev_b32 v18, 16, v160
    s_waitcnt lgkmcnt(8)
    v_mfma_f32_32x32x16_bf16 a[16:31], v[26:29], v[154:157], a[16:31]
    ds_read_b64_tr_b16 v[26:27], v10 offset:1888
    ds_read_b64_tr_b16 v[28:29], v10 offset:2784
    v_and_b32 v19, s68, v160
    v_lshlrev_b32 v20, 16, v161
    v_and_b32 v21, s68, v161
    v_fma_f32 v14, v14, v12, v13
    v_fma_f32 v15, v15, v12, v13
    s_waitcnt lgkmcnt(8)
    v_mfma_f32_32x32x16_bf16 a[32:47], v[30:33], v[154:157], a[32:47]
    ds_read_b64_tr_b16 v[30:31], v10 offset:1920
    ds_read_b64_tr_b16 v[32:33], v10 offset:2816
    v_fma_f32 v16, v16, v12, v13
    v_fma_f32 v17, v17, v12, v13
    v_fma_f32 v18, v18, v12, v13
    v_fma_f32 v19, v19, v12, v13
    v_fma_f32 v20, v20, v12, v13
    s_waitcnt lgkmcnt(8)
    v_mfma_f32_32x32x16_bf16 a[48:63], v[34:37], v[154:157], a[48:63]
    ds_read_b64_tr_b16 v[34:35], v10 offset:1952
    ds_read_b64_tr_b16 v[36:37], v10 offset:2848
    v_fma_f32 v21, v21, v12, v13
    v_cvt_pk_bf16_f32 v158, v14, v15
    v_cvt_pk_bf16_f32 v159, v16, v17
    v_cvt_pk_bf16_f32 v160, v18, v19
    v_cvt_pk_bf16_f32 v161, v20, v21
    s_waitcnt lgkmcnt(8)
    v_mfma_f32_32x32x16_bf16 a[64:79], v[38:41], v[154:157], a[64:79]
    ds_read_b64_tr_b16 v[38:39], v10 offset:1984
    ds_read_b64_tr_b16 v[40:41], v10 offset:2880
    s_waitcnt vmcnt(1)
    s_barrier
    v_add_u32 v10, 0, v8
    v_add_u32 v11, 0, v9
    s_waitcnt lgkmcnt(8)
    v_mfma_f32_32x32x16_bf16 a[0:15], v[22:25], v[158:161], a[0:15]
    ds_read_b64_tr_b16 v[22:23], v10 offset:64
    ds_read_b64_tr_b16 v[24:25], v10 offset:960
    v_lshlrev_b32 v14, 16, v162
    v_and_b32 v15, s68, v162
    v_lshlrev_b32 v16, 16, v163
    v_and_b32 v17, s68, v163
    v_lshlrev_b32 v18, 16, v164
    s_waitcnt lgkmcnt(8)
    v_mfma_f32_32x32x16_bf16 a[16:31], v[26:29], v[158:161], a[16:31]
    ds_read_b64_tr_b16 v[26:27], v10 offset:96
    ds_read_b64_tr_b16 v[28:29], v10 offset:992
    v_and_b32 v19, s68, v164
    v_lshlrev_b32 v20, 16, v165
    v_and_b32 v21, s68, v165
    v_fma_f32 v14, v14, v12, v13
    v_fma_f32 v15, v15, v12, v13
    s_waitcnt lgkmcnt(8)
    v_mfma_f32_32x32x16_bf16 a[32:47], v[30:33], v[158:161], a[32:47]
    ds_read_b64_tr_b16 v[30:31], v10 offset:128
    ds_read_b64_tr_b16 v[32:33], v10 offset:1024
    v_fma_f32 v16, v16, v12, v13
    v_fma_f32 v17, v17, v12, v13
    v_fma_f32 v18, v18, v12, v13
    v_fma_f32 v19, v19, v12, v13
    v_fma_f32 v20, v20, v12, v13
    s_waitcnt lgkmcnt(8)
    v_mfma_f32_32x32x16_bf16 a[48:63], v[34:37], v[158:161], a[48:63]
    ds_read_b64_tr_b16 v[34:35], v10 offset:160
    ds_read_b64_tr_b16 v[36:37], v10 offset:1056
    v_fma_f32 v21, v21, v12, v13
    v_cvt_pk_bf16_f32 v162, v14, v15
    v_cvt_pk_bf16_f32 v163, v16, v17
    v_cvt_pk_bf16_f32 v164, v18, v19
    v_cvt_pk_bf16_f32 v165, v20, v21
    s_waitcnt lgkmcnt(8)
    v_mfma_f32_32x32x16_bf16 a[64:79], v[38:41], v[158:161], a[64:79]
    ds_read_b64_tr_b16 v[38:39], v10 offset:192
    ds_read_b64_tr_b16 v[40:41], v10 offset:1088
    s_waitcnt lgkmcnt(8)
    v_mfma_f32_32x32x16_bf16 a[0:15], v[22:25], v[162:165], a[0:15]
    ds_read_b64_tr_b16 v[22:23], v10 offset:1856
    ds_read_b64_tr_b16 v[24:25], v10 offset:2752
    v_lshlrev_b32 v14, 16, v166
    v_and_b32 v15, s68, v166
    v_lshlrev_b32 v16, 16, v167
    v_and_b32 v17, s68, v167
    v_lshlrev_b32 v18, 16, v168
    s_waitcnt lgkmcnt(8)
    v_mfma_f32_32x32x16_bf16 a[16:31], v[26:29], v[162:165], a[16:31]
    ds_read_b64_tr_b16 v[26:27], v10 offset:1888
    ds_read_b64_tr_b16 v[28:29], v10 offset:2784
    v_and_b32 v19, s68, v168
    v_lshlrev_b32 v20, 16, v169
    v_and_b32 v21, s68, v169
    v_fma_f32 v14, v14, v12, v13
    v_fma_f32 v15, v15, v12, v13
    s_waitcnt lgkmcnt(8)
    v_mfma_f32_32x32x16_bf16 a[32:47], v[30:33], v[162:165], a[32:47]
    ds_read_b64_tr_b16 v[30:31], v10 offset:1920
    ds_read_b64_tr_b16 v[32:33], v10 offset:2816
    v_fma_f32 v16, v16, v12, v13
    v_fma_f32 v17, v17, v12, v13
    v_fma_f32 v18, v18, v12, v13
    v_fma_f32 v19, v19, v12, v13
    v_fma_f32 v20, v20, v12, v13
    s_waitcnt lgkmcnt(8)
    v_mfma_f32_32x32x16_bf16 a[48:63], v[34:37], v[162:165], a[48:63]
    ds_read_b64_tr_b16 v[34:35], v10 offset:1952
    ds_read_b64_tr_b16 v[36:37], v10 offset:2848
    v_fma_f32 v21, v21, v12, v13
    v_cvt_pk_bf16_f32 v166, v14, v15
    v_cvt_pk_bf16_f32 v167, v16, v17
    v_cvt_pk_bf16_f32 v168, v18, v19
    v_cvt_pk_bf16_f32 v169, v20, v21
    s_waitcnt lgkmcnt(8)
    v_mfma_f32_32x32x16_bf16 a[64:79], v[38:41], v[162:165], a[64:79]
    ds_read_b64_tr_b16 v[38:39], v10 offset:1984
    ds_read_b64_tr_b16 v[40:41], v10 offset:2880
    s_waitcnt lgkmcnt(8)
    v_mfma_f32_32x32x16_bf16 a[0:15], v[22:25], v[166:169], a[0:15]
    s_waitcnt lgkmcnt(6)
    v_mfma_f32_32x32x16_bf16 a[16:31], v[26:29], v[166:169], a[16:31]
    s_waitcnt lgkmcnt(4)
    v_mfma_f32_32x32x16_bf16 a[32:47], v[30:33], v[166:169], a[32:47]
    s_waitcnt lgkmcnt(2)
    v_mfma_f32_32x32x16_bf16 a[48:63], v[34:37], v[166:169], a[48:63]
    s_waitcnt lgkmcnt(0)
    v_mfma_f32_32x32x16_bf16 a[64:79], v[38:41], v[166:169], a[64:79]
    v_mov_b32 v14, 0xc0135761
    v_mov_b32 v15, 0xbdd2d3e8
    s_nop 7
    s_nop 3
    v_accvgpr_read_b32 v42, a0
    v_accvgpr_read_b32 v43, a1
    v_accvgpr_read_b32 v44, a2
    v_accvgpr_read_b32 v45, a3
    v_accvgpr_read_b32 v46, a4
    v_accvgpr_read_b32 v47, a5
    v_accvgpr_read_b32 v48, a6
    v_accvgpr_read_b32 v49, a7
    v_accvgpr_read_b32 v50, a8
    v_accvgpr_read_b32 v51, a9
    v_accvgpr_read_b32 v52, a10
    v_accvgpr_read_b32 v53, a11
    v_accvgpr_read_b32 v54, a12
    v_accvgpr_read_b32 v55, a13
    v_accvgpr_read_b32 v56, a14
    v_accvgpr_read_b32 v57, a15
    v_mul_f32 v58, v42, v42
    v_mul_f32 v59, v43, v43
    v_mul_f32 v60, v44, v44
    v_mul_f32 v61, v45, v45
    v_mul_f32 v62, v46, v46
    v_mul_f32 v63, v47, v47
    v_mul_f32 v64, v48, v48
    v_mul_f32 v65, v49, v49
    v_fma_f32 v58, v58, v15, v14
    v_fma_f32 v59, v59, v15, v14
    v_fma_f32 v60, v60, v15, v14
    v_fma_f32 v61, v61, v15, v14
    v_fma_f32 v62, v62, v15, v14
    v_fma_f32 v63, v63, v15, v14
    v_fma_f32 v64, v64, v15, v14
    v_fma_f32 v65, v65, v15, v14
    v_mul_f32 v58, v42, v58
    v_mul_f32 v59, v43, v59
    v_mul_f32 v60, v44, v60
    v_mul_f32 v61, v45, v61
    v_mul_f32 v62, v46, v62
    v_mul_f32 v63, v47, v63
    v_mul_f32 v64, v48, v64
    v_mul_f32 v65, v49, v65
    v_exp_f32 v58, v58
    v_exp_f32 v59, v59
    v_exp_f32 v60, v60
    v_exp_f32 v61, v61
    v_exp_f32 v62, v62
    v_exp_f32 v63, v63
    v_exp_f32 v64, v64
    v_exp_f32 v65, v65
    v_mul_f32 v50, v42, v50
    v_mul_f32 v51, v43, v51
    v_mul_f32 v52, v44, v52
    v_mul_f32 v53, v45, v53
    v_mul_f32 v54, v46, v54
    v_mul_f32 v55, v47, v55
    v_mul_f32 v56, v48, v56
    v_mul_f32 v57, v49, v57
    v_add_f32 v58, 1.0, v58
    v_add_f32 v59, 1.0, v59
    v_add_f32 v60, 1.0, v60
    v_add_f32 v61, 1.0, v61
    v_add_f32 v62, 1.0, v62
    v_add_f32 v63, 1.0, v63
    v_add_f32 v64, 1.0, v64
    v_add_f32 v65, 1.0, v65
    v_rcp_f32 v58, v58
    v_rcp_f32 v59, v59
    v_rcp_f32 v60, v60
    v_rcp_f32 v61, v61
    v_rcp_f32 v62, v62
    v_rcp_f32 v63, v63
    v_rcp_f32 v64, v64
    v_rcp_f32 v65, v65
    s_nop 0
    v_mul_f32 v50, v50, v58
    v_mul_f32 v51, v51, v59
    v_mul_f32 v52, v52, v60
    v_mul_f32 v53, v53, v61
    v_mul_f32 v54, v54, v62
    v_mul_f32 v55, v55, v63
    v_mul_f32 v56, v56, v64
    v_mul_f32 v57, v57, v65
    v_cvt_pk_bf16_f32 v42, v50, v51
    v_cvt_pk_bf16_f32 v43, v52, v53
    v_cvt_pk_bf16_f32 v44, v54, v55
    v_cvt_pk_bf16_f32 v45, v56, v57
    buffer_store_dwordx4 v[42:45], v2, s[12:15], s70 offen offset:2048 sc1
    v_accvgpr_read_b32 v66, a16
    v_accvgpr_read_b32 v67, a17
    v_accvgpr_read_b32 v68, a18
    v_accvgpr_read_b32 v69, a19
    v_accvgpr_read_b32 v70, a20
    v_accvgpr_read_b32 v71, a21
    v_accvgpr_read_b32 v72, a22
    v_accvgpr_read_b32 v73, a23
    v_accvgpr_read_b32 v74, a24
    v_accvgpr_read_b32 v75, a25
    v_accvgpr_read_b32 v76, a26
    v_accvgpr_read_b32 v77, a27
    v_accvgpr_read_b32 v78, a28
    v_accvgpr_read_b32 v79, a29
    v_accvgpr_read_b32 v80, a30
    v_accvgpr_read_b32 v81, a31
    v_mul_f32 v82, v66, v66
    v_mul_f32 v83, v67, v67
    v_mul_f32 v84, v68, v68
    v_mul_f32 v85, v69, v69
    v_mul_f32 v86, v70, v70
    v_mul_f32 v87, v71, v71
    v_mul_f32 v88, v72, v72
    v_mul_f32 v89, v73, v73
    v_fma_f32 v82, v82, v15, v14
    v_fma_f32 v83, v83, v15, v14
    v_fma_f32 v84, v84, v15, v14
    v_fma_f32 v85, v85, v15, v14
    v_fma_f32 v86, v86, v15, v14
    v_fma_f32 v87, v87, v15, v14
    v_fma_f32 v88, v88, v15, v14
    v_fma_f32 v89, v89, v15, v14
    v_mul_f32 v82, v66, v82
    v_mul_f32 v83, v67, v83
    v_mul_f32 v84, v68, v84
    v_mul_f32 v85, v69, v85
    v_mul_f32 v86, v70, v86
    v_mul_f32 v87, v71, v87
    v_mul_f32 v88, v72, v88
    v_mul_f32 v89, v73, v89
    v_exp_f32 v82, v82
    v_exp_f32 v83, v83
    v_exp_f32 v84, v84
    v_exp_f32 v85, v85
    v_exp_f32 v86, v86
    v_exp_f32 v87, v87
    v_exp_f32 v88, v88
    v_exp_f32 v89, v89
    v_mul_f32 v74, v66, v74
    v_mul_f32 v75, v67, v75
    v_mul_f32 v76, v68, v76
    v_mul_f32 v77, v69, v77
    v_mul_f32 v78, v70, v78
    v_mul_f32 v79, v71, v79
    v_mul_f32 v80, v72, v80
    v_mul_f32 v81, v73, v81
    v_add_f32 v82, 1.0, v82
    v_add_f32 v83, 1.0, v83
    v_add_f32 v84, 1.0, v84
    v_add_f32 v85, 1.0, v85
    v_add_f32 v86, 1.0, v86
    v_add_f32 v87, 1.0, v87
    v_add_f32 v88, 1.0, v88
    v_add_f32 v89, 1.0, v89
    v_rcp_f32 v82, v82
    v_rcp_f32 v83, v83
    v_rcp_f32 v84, v84
    v_rcp_f32 v85, v85
    v_rcp_f32 v86, v86
    v_rcp_f32 v87, v87
    v_rcp_f32 v88, v88
    v_rcp_f32 v89, v89
    s_nop 0
    v_mul_f32 v74, v74, v82
    v_mul_f32 v75, v75, v83
    v_mul_f32 v76, v76, v84
    v_mul_f32 v77, v77, v85
    v_mul_f32 v78, v78, v86
    v_mul_f32 v79, v79, v87
    v_mul_f32 v80, v80, v88
    v_mul_f32 v81, v81, v89
    v_cvt_pk_bf16_f32 v66, v74, v75
    v_cvt_pk_bf16_f32 v67, v76, v77
    v_cvt_pk_bf16_f32 v68, v78, v79
    v_cvt_pk_bf16_f32 v69, v80, v81
    buffer_store_dwordx4 v[66:69], v2, s[12:15], s70 offen offset:3072 sc1
    v_accvgpr_read_b32 v90, a32
    v_accvgpr_read_b32 v91, a33
    v_accvgpr_read_b32 v92, a34
    v_accvgpr_read_b32 v93, a35
    v_accvgpr_read_b32 v94, a36
    v_accvgpr_read_b32 v95, a37
    v_accvgpr_read_b32 v96, a38
    v_accvgpr_read_b32 v97, a39
    v_accvgpr_read_b32 v98, a40
    v_accvgpr_read_b32 v99, a41
    v_accvgpr_read_b32 v100, a42
    v_accvgpr_read_b32 v101, a43
    v_accvgpr_read_b32 v102, a44
    v_accvgpr_read_b32 v103, a45
    v_accvgpr_read_b32 v104, a46
    v_accvgpr_read_b32 v105, a47
    v_mul_f32 v106, v90, v90
    v_mul_f32 v107, v91, v91
    v_mul_f32 v108, v92, v92
    v_mul_f32 v109, v93, v93
    v_mul_f32 v110, v94, v94
    v_mul_f32 v111, v95, v95
    v_mul_f32 v112, v96, v96
    v_mul_f32 v113, v97, v97
    v_fma_f32 v106, v106, v15, v14
    v_fma_f32 v107, v107, v15, v14
    v_fma_f32 v108, v108, v15, v14
    v_fma_f32 v109, v109, v15, v14
    v_fma_f32 v110, v110, v15, v14
    v_fma_f32 v111, v111, v15, v14
    v_fma_f32 v112, v112, v15, v14
    v_fma_f32 v113, v113, v15, v14
    v_mul_f32 v106, v90, v106
    v_mul_f32 v107, v91, v107
    v_mul_f32 v108, v92, v108
    v_mul_f32 v109, v93, v109
    v_mul_f32 v110, v94, v110
    v_mul_f32 v111, v95, v111
    v_mul_f32 v112, v96, v112
    v_mul_f32 v113, v97, v113
    v_exp_f32 v106, v106
    v_exp_f32 v107, v107
    v_exp_f32 v108, v108
    v_exp_f32 v109, v109
    v_exp_f32 v110, v110
    v_exp_f32 v111, v111
    v_exp_f32 v112, v112
    v_exp_f32 v113, v113
    v_mul_f32 v98, v90, v98
    v_mul_f32 v99, v91, v99
    v_mul_f32 v100, v92, v100
    v_mul_f32 v101, v93, v101
    v_mul_f32 v102, v94, v102
    v_mul_f32 v103, v95, v103
    v_mul_f32 v104, v96, v104
    v_mul_f32 v105, v97, v105
    v_add_f32 v106, 1.0, v106
    v_add_f32 v107, 1.0, v107
    v_add_f32 v108, 1.0, v108
    v_add_f32 v109, 1.0, v109
    v_add_f32 v110, 1.0, v110
    v_add_f32 v111, 1.0, v111
    v_add_f32 v112, 1.0, v112
    v_add_f32 v113, 1.0, v113
    v_rcp_f32 v106, v106
    v_rcp_f32 v107, v107
    v_rcp_f32 v108, v108
    v_rcp_f32 v109, v109
    v_rcp_f32 v110, v110
    v_rcp_f32 v111, v111
    v_rcp_f32 v112, v112
    v_rcp_f32 v113, v113
    s_nop 0
    v_mul_f32 v98, v98, v106
    v_mul_f32 v99, v99, v107
    v_mul_f32 v100, v100, v108
    v_mul_f32 v101, v101, v109
    v_mul_f32 v102, v102, v110
    v_mul_f32 v103, v103, v111
    v_mul_f32 v104, v104, v112
    v_mul_f32 v105, v105, v113
    v_cvt_pk_bf16_f32 v90, v98, v99
    v_cvt_pk_bf16_f32 v91, v100, v101
    v_cvt_pk_bf16_f32 v92, v102, v103
    v_cvt_pk_bf16_f32 v93, v104, v105
    buffer_store_dwordx4 v[90:93], v2, s[12:15], s71 offen offset:0 sc1
    v_accvgpr_read_b32 v114, a48
    v_accvgpr_read_b32 v115, a49
    v_accvgpr_read_b32 v116, a50
    v_accvgpr_read_b32 v117, a51
    v_accvgpr_read_b32 v118, a52
    v_accvgpr_read_b32 v119, a53
    v_accvgpr_read_b32 v120, a54
    v_accvgpr_read_b32 v121, a55
    v_accvgpr_read_b32 v122, a56
    v_accvgpr_read_b32 v123, a57
    v_accvgpr_read_b32 v124, a58
    v_accvgpr_read_b32 v125, a59
    v_accvgpr_read_b32 v126, a60
    v_accvgpr_read_b32 v127, a61
    v_accvgpr_read_b32 v128, a62
    v_accvgpr_read_b32 v129, a63
    v_mul_f32 v130, v114, v114
    v_mul_f32 v131, v115, v115
    v_mul_f32 v132, v116, v116
    v_mul_f32 v133, v117, v117
    v_mul_f32 v134, v118, v118
    v_mul_f32 v135, v119, v119
    v_mul_f32 v136, v120, v120
    v_mul_f32 v137, v121, v121
    v_fma_f32 v130, v130, v15, v14
    v_fma_f32 v131, v131, v15, v14
    v_fma_f32 v132, v132, v15, v14
    v_fma_f32 v133, v133, v15, v14
    v_fma_f32 v134, v134, v15, v14
    v_fma_f32 v135, v135, v15, v14
    v_fma_f32 v136, v136, v15, v14
    v_fma_f32 v137, v137, v15, v14
    v_mul_f32 v130, v114, v130
    v_mul_f32 v131, v115, v131
    v_mul_f32 v132, v116, v132
    v_mul_f32 v133, v117, v133
    v_mul_f32 v134, v118, v134
    v_mul_f32 v135, v119, v135
    v_mul_f32 v136, v120, v136
    v_mul_f32 v137, v121, v137
    v_exp_f32 v130, v130
    v_exp_f32 v131, v131
    v_exp_f32 v132, v132
    v_exp_f32 v133, v133
    v_exp_f32 v134, v134
    v_exp_f32 v135, v135
    v_exp_f32 v136, v136
    v_exp_f32 v137, v137
    v_mul_f32 v122, v114, v122
    v_mul_f32 v123, v115, v123
    v_mul_f32 v124, v116, v124
    v_mul_f32 v125, v117, v125
    v_mul_f32 v126, v118, v126
    v_mul_f32 v127, v119, v127
    v_mul_f32 v128, v120, v128
    v_mul_f32 v129, v121, v129
    v_add_f32 v130, 1.0, v130
    v_add_f32 v131, 1.0, v131
    v_add_f32 v132, 1.0, v132
    v_add_f32 v133, 1.0, v133
    v_add_f32 v134, 1.0, v134
    v_add_f32 v135, 1.0, v135
    v_add_f32 v136, 1.0, v136
    v_add_f32 v137, 1.0, v137
    v_rcp_f32 v130, v130
    v_rcp_f32 v131, v131
    v_rcp_f32 v132, v132
    v_rcp_f32 v133, v133
    v_rcp_f32 v134, v134
    v_rcp_f32 v135, v135
    v_rcp_f32 v136, v136
    v_rcp_f32 v137, v137
    s_nop 0
    v_mul_f32 v122, v122, v130
    v_mul_f32 v123, v123, v131
    v_mul_f32 v124, v124, v132
    v_mul_f32 v125, v125, v133
    v_mul_f32 v126, v126, v134
    v_mul_f32 v127, v127, v135
    v_mul_f32 v128, v128, v136
    v_mul_f32 v129, v129, v137
    v_cvt_pk_bf16_f32 v114, v122, v123
    v_cvt_pk_bf16_f32 v115, v124, v125
    v_cvt_pk_bf16_f32 v116, v126, v127
    v_cvt_pk_bf16_f32 v117, v128, v129
    buffer_store_dwordx4 v[114:117], v2, s[12:15], s71 offen offset:1024 sc1
    v_accvgpr_read_b32 v138, a64
    v_accvgpr_read_b32 v139, a65
    v_accvgpr_read_b32 v140, a66
    v_accvgpr_read_b32 v141, a67
    v_accvgpr_read_b32 v142, a68
    v_accvgpr_read_b32 v143, a69
    v_accvgpr_read_b32 v144, a70
    v_accvgpr_read_b32 v145, a71
    v_accvgpr_read_b32 v146, a72
    v_accvgpr_read_b32 v147, a73
    v_accvgpr_read_b32 v148, a74
    v_accvgpr_read_b32 v149, a75
    v_accvgpr_read_b32 v150, a76
    v_accvgpr_read_b32 v151, a77
    v_accvgpr_read_b32 v152, a78
    v_accvgpr_read_b32 v153, a79
    v_mul_f32 v154, v138, v138
    v_mul_f32 v155, v139, v139
    v_mul_f32 v156, v140, v140
    v_mul_f32 v157, v141, v141
    v_mul_f32 v158, v142, v142
    v_mul_f32 v159, v143, v143
    v_mul_f32 v160, v144, v144
    v_mul_f32 v161, v145, v145
    v_fma_f32 v154, v154, v15, v14
    v_fma_f32 v155, v155, v15, v14
    v_fma_f32 v156, v156, v15, v14
    v_fma_f32 v157, v157, v15, v14
    v_fma_f32 v158, v158, v15, v14
    v_fma_f32 v159, v159, v15, v14
    v_fma_f32 v160, v160, v15, v14
    v_fma_f32 v161, v161, v15, v14
    v_mul_f32 v154, v138, v154
    v_mul_f32 v155, v139, v155
    v_mul_f32 v156, v140, v156
    v_mul_f32 v157, v141, v157
    v_mul_f32 v158, v142, v158
    v_mul_f32 v159, v143, v159
    v_mul_f32 v160, v144, v160
    v_mul_f32 v161, v145, v161
    v_exp_f32 v154, v154
    v_exp_f32 v155, v155
    v_exp_f32 v156, v156
    v_exp_f32 v157, v157
    v_exp_f32 v158, v158
    v_exp_f32 v159, v159
    v_exp_f32 v160, v160
    v_exp_f32 v161, v161
    v_mul_f32 v146, v138, v146
    v_mul_f32 v147, v139, v147
    v_mul_f32 v148, v140, v148
    v_mul_f32 v149, v141, v149
    v_mul_f32 v150, v142, v150
    v_mul_f32 v151, v143, v151
    v_mul_f32 v152, v144, v152
    v_mul_f32 v153, v145, v153
    v_add_f32 v154, 1.0, v154
    v_add_f32 v155, 1.0, v155
    v_add_f32 v156, 1.0, v156
    v_add_f32 v157, 1.0, v157
    v_add_f32 v158, 1.0, v158
    v_add_f32 v159, 1.0, v159
    v_add_f32 v160, 1.0, v160
    v_add_f32 v161, 1.0, v161
    v_rcp_f32 v154, v154
    v_rcp_f32 v155, v155
    v_rcp_f32 v156, v156
    v_rcp_f32 v157, v157
    v_rcp_f32 v158, v158
    v_rcp_f32 v159, v159
    v_rcp_f32 v160, v160
    v_rcp_f32 v161, v161
    s_nop 0
    v_mul_f32 v146, v146, v154
    v_mul_f32 v147, v147, v155
    v_mul_f32 v148, v148, v156
    v_mul_f32 v149, v149, v157
    v_mul_f32 v150, v150, v158
    v_mul_f32 v151, v151, v159
    v_mul_f32 v152, v152, v160
    v_mul_f32 v153, v153, v161
    v_cvt_pk_bf16_f32 v138, v146, v147
    v_cvt_pk_bf16_f32 v139, v148, v149
    v_cvt_pk_bf16_f32 v140, v150, v151
    v_cvt_pk_bf16_f32 v141, v152, v153
    buffer_store_dwordx4 v[138:141], v2, s[12:15], s71 offen offset:2048 sc1
k1_kernel_end:
    s_endpgm
.p2align 8
.globl k2_kernel
.type k2_kernel,@function
k2_kernel:
    s_cmp_ge_u32 s2, 256
    s_cbranch_scc1 k2_kernel_end
    s_load_dwordx2 s[6:7], s[0:1], 72
    v_lshrrev_b32 v2, 6, v0
    v_and_b32 v1, 63, v0
    s_nop 0
    v_readfirstlane_b32 s3, v2
    s_and_b32 s4, s2, 31
    s_lshr_b32 s5, s2, 5
    v_lshlrev_b32 v2, 4, v1
    s_waitcnt lgkmcnt(0)
    s_mov_b32 s8, s6
    s_and_b32 s9, s7, 0xffff
    s_mov_b32 s10, 33554432
    s_mov_b32 s11, 0x00020000
    s_cmp_ge_u32 s3, 8
    s_cbranch_scc1 k2_kernel_gemm
    s_lshl_b32 s12, s4, 16
    s_lshl_b32 s13, s3, 10
    s_add_u32 s12, s12, s13
    s_add_u32 s14, s12, 2097152
    s_mov_b32 m0, s13
    s_nop 0
    buffer_load_dwordx4 v2, s[8:11], s14 offen lds
    s_add_u32 s14, s12, 4194304
    s_add_u32 m0, s13, 65536
    s_nop 0
    buffer_load_dwordx4 v2, s[8:11], s14 offen lds
    s_lshl_b32 s19, s5, 3
    s_add_u32 s19, s19, s3
    s_lshl_b32 s14, s4, 6
    s_add_u32 s14, s14, s19
    s_lshl_b32 s14, s14, 10
    buffer_load_dwordx4 v[12:15], v2, s[8:11], s14 offen
    s_mov_b32 s24, s12
    s_mov_b32 s26, s13
    s_lshl_b32 s19, s19, 5
    s_add_u32 s19, s19, s4
    s_lshl_b32 s19, s19, 10
    s_add_u32 s19, s19, 6291456
    s_mov_b32 s16, 0x0000ffff
    s_mov_b32 s17, 0x0000ffff
    v_mov_b32 v3, v2
    v_lshrrev_b32 v5, 5, v1
    v_and_b32 v6, 15, v1
    v_lshlrev_b32 v4, 8, v5
    v_lshl_add_u32 v4, v6, 4, v4
    v_add_u32 v4, 65536, v4
    v_and_b32 v5, 31, v1
    v_and_b32 v6, 27, v5
    v_mov_b32 v7, 0x3f803f80
    v_cmp_eq_u32 vcc, 16, v6
    s_nop 1
    v_cndmask_b32 v5, 0, v7, vcc
    v_mov_b32 v24, v5
    v_mov_b32 v25, v5
    v_mov_b32 v26, v5
    v_mov_b32 v27, v5
    v_mov_b32 v28, v5
    v_mov_b32 v29, v5
    v_mov_b32 v30, v5
    v_mov_b32 v31, v5
    v_mov_b32 v32, v5
    v_mov_b32 v33, v5
    v_mov_b32 v34, v5
    v_mov_b32 v35, v5
    v_mov_b32 v36, v5
    v_mov_b32 v37, v5
    v_mov_b32 v38, v5
    v_mov_b32 v39, v5
    s_waitcnt vmcnt(0)
    s_barrier
    ds_read_b128 v[16:19], v3 offset:0
    ds_read_b128 v[20:23], v3 offset:1024
    ds_read_b128 v[40:43], v3 offset:2048
    ds_read_b128 v[44:47], v3 offset:3072
    s_add_u32 s14, s24, 2105344
    s_add_u32 m0, s26, 8192
    s_nop 0
    buffer_load_dwordx4 v2, s[8:11], s14 offen lds
    s_add_u32 s14, s24, 4202496
    s_add_u32 m0, s26, 73728
    s_nop 0
    buffer_load_dwordx4 v2, s[8:11], s14 offen lds
    s_add_u32 s14, s24, 2113536
    s_add_u32 m0, s26, 16384
    s_nop 0
    buffer_load_dwordx4 v2, s[8:11], s14 offen lds
    s_add_u32 s14, s24, 4210688
    s_add_u32 m0, s26, 81920
    s_nop 0
    buffer_load_dwordx4 v2, s[8:11], s14 offen lds
    s_add_u32 s14, s24, 2121728
    s_add_u32 m0, s26, 24576
    s_nop 0
    buffer_load_dwordx4 v2, s[8:11], s14 offen lds
    s_add_u32 s14, s24, 4218880
    s_add_u32 m0, s26, 90112
    s_nop 0
    buffer_load_dwordx4 v2, s[8:11], s14 offen lds
    s_waitcnt lgkmcnt(0)
    v_mfma_f32_32x32x16_bf16 v[48:63], v[16:19], v[12:15], 0
    v_mfma_f32_32x32x16_bf16 v[64:79], v[20:23], v[12:15], 0
    v_mfma_f32_32x32x16_bf16 v[80:95], v[40:43], v[12:15], 0
    v_mfma_f32_32x32x16_bf16 v[96:111], v[44:47], v[12:15], 0
    s_add_u32 s14, s24, 2129920
    s_add_u32 m0, s26, 32768
    s_nop 0
    buffer_load_dwordx4 v2, s[8:11], s14 offen lds
    s_add_u32 s14, s24, 4227072
    s_add_u32 m0, s26, 98304
    s_nop 0
    buffer_load_dwordx4 v2, s[8:11], s14 offen lds
    s_add_u32 s14, s24, 2138112
    s_add_u32 m0, s26, 40960
    s_nop 0
    buffer_load_dwordx4 v2, s[8:11], s14 offen lds
    s_add_u32 s14, s24, 4235264
    s_add_u32 m0, s26, 106496
    s_nop 0
    buffer_load_dwordx4 v2, s[8:11], s14 offen lds
    s_add_u32 s14, s24, 2146304
    s_add_u32 m0, s26, 49152
    s_nop 0
    buffer_load_dwordx4 v2, s[8:11], s14 offen lds
    s_add_u32 s14, s24, 4243456
    s_add_u32 m0, s26, 114688
    s_nop 0
    buffer_load_dwordx4 v2, s[8:11], s14 offen lds
    s_add_u32 s14, s24, 2154496
    s_add_u32 m0, s26, 57344
    s_nop 0
    buffer_load_dwordx4 v2, s[8:11], s14 offen lds
    s_add_u32 s14, s24, 4251648
    s_add_u32 m0, s26, 122880
    s_nop 0
    buffer_load_dwordx4 v2, s[8:11], s14 offen lds
    v_max3_f32 v5, v48, v49, v48
    v_max3_f32 v5, v50, v51, v5
    v_max3_f32 v5, v52, v53, v5
    v_max3_f32 v5, v54, v55, v5
    v_max3_f32 v5, v56, v57, v5
    v_max3_f32 v5, v58, v59, v5
    v_max3_f32 v5, v60, v61, v5
    v_max3_f32 v5, v62, v63, v5
    v_max3_f32 v5, v64, v65, v5
    v_max3_f32 v5, v66, v67, v5
    v_max3_f32 v5, v68, v69, v5
    v_max3_f32 v5, v70, v71, v5
    v_max3_f32 v5, v72, v73, v5
    v_max3_f32 v5, v74, v75, v5
    v_max3_f32 v5, v76, v77, v5
    v_max3_f32 v5, v78, v79, v5
    v_max3_f32 v5, v80, v81, v5
    v_max3_f32 v5, v82, v83, v5
    v_max3_f32 v5, v84, v85, v5
    v_max3_f32 v5, v86, v87, v5
    v_max3_f32 v5, v88, v89, v5
    v_max3_f32 v5, v90, v91, v5
    v_max3_f32 v5, v92, v93, v5
    v_max3_f32 v5, v94, v95, v5
    v_max3_f32 v5, v96, v97, v5
    v_max3_f32 v5, v98, v99, v5
    v_max3_f32 v5, v100, v101, v5
    v_max3_f32 v5, v102, v103, v5
    v_max3_f32 v5, v104, v105, v5
    v_max3_f32 v5, v106, v107, v5
    v_max3_f32 v5, v108, v109, v5
    v_max3_f32 v5, v110, v111, v5
    v_mov_b32 v96, 0
    v_mov_b32 v97, 0
    v_mov_b32 v98, 0
    v_mov_b32 v99, 0
    v_mov_b32 v100, 0
    v_mov_b32 v101, 0
    v_mov_b32 v102, 0
    v_mov_b32 v103, 0
    v_mov_b32 v104, 0
    v_mov_b32 v105, 0
    v_mov_b32 v106, 0
    v_mov_b32 v107, 0
    v_mov_b32 v108, 0
    v_mov_b32 v109, 0
    v_mov_b32 v110, 0
    v_mov_b32 v111, 0
    s_nop 0
    v_mov_b32 v6, v5
    s_nop 1
    v_permlane32_swap_b32 v5, v6
    s_nop 1
    v_max_f32 v5, v5, v6
    v_add_f32 v5, 0x42200000, v5
    v_sub_f32 v5, 0, v5
    ds_read_b128 v[16:19], v3 offset:0
    ds_read_b128 v[20:23], v3 offset:1024
    s_mov_b64 exec, s[16:17]
    ds_read_b128 v[24:27], v4 offset:0
    ds_read_b128 v[28:31], v4 offset:512
    s_mov_b64 exec, -1
    v_mov_b32 v80, v5
    v_mov_b32 v81, v5
    v_mov_b32 v82, v5
    v_mov_b32 v83, v5
    v_mov_b32 v84, v5
    v_mov_b32 v85, v5
    v_mov_b32 v86, v5
    v_mov_b32 v87, v5
    v_mov_b32 v88, v5
    v_mov_b32 v89, v5
    v_mov_b32 v90, v5
    v_mov_b32 v91, v5
    v_mov_b32 v92, v5
    v_mov_b32 v93, v5
    v_mov_b32 v94, v5
    v_mov_b32 v95, v5
    s_nop 0
    s_waitcnt lgkmcnt(0)
    v_mfma_f32_32x32x16_bf16 v[48:63], v[16:19], v[12:15], v[80:95]
    s_nop 7
    s_nop 3
    s_waitcnt lgkmcnt(0)
    v_mfma_f32_32x32x16_bf16 v[64:79], v[20:23], v[12:15], v[80:95]
    ds_read_b128 v[16:19], v3 offset:2048
    s_mov_b64 exec, s[16:17]
    ds_read_b128 v[32:35], v4 offset:1024
    ds_read_b128 v[36:39], v4 offset:1536
    s_mov_b64 exec, -1
    v_exp_f32 v48, v48
    v_exp_f32 v49, v49
    v_exp_f32 v50, v50
    v_exp_f32 v51, v51
    v_exp_f32 v52, v52
    v_exp_f32 v53, v53
    v_exp_f32 v54, v54
    v_exp_f32 v55, v55
    v_cvt_pk_bf16_f32 v40, v48, v49
    v_cvt_pk_bf16_f32 v41, v50, v51
    v_cvt_pk_bf16_f32 v42, v52, v53
    v_cvt_pk_bf16_f32 v43, v54, v55
    v_exp_f32 v56, v56
    v_exp_f32 v57, v57
    v_mfma_f32_32x32x16_bf16 v[96:111], v[24:27], v[40:43], v[96:111]
    v_exp_f32 v58, v58
    v_exp_f32 v59, v59
    v_exp_f32 v60, v60
    v_exp_f32 v61, v61
    v_exp_f32 v62, v62
    v_exp_f32 v63, v63
    v_cvt_pk_bf16_f32 v44, v56, v57
    v_cvt_pk_bf16_f32 v45, v58, v59
    v_cvt_pk_bf16_f32 v46, v60, v61
    v_cvt_pk_bf16_f32 v47, v62, v63
    s_nop 1
    v_mfma_f32_32x32x16_bf16 v[96:111], v[28:31], v[44:47], v[96:111]
    s_waitcnt lgkmcnt(0)
    v_mfma_f32_32x32x16_bf16 v[48:63], v[16:19], v[12:15], v[80:95]
    ds_read_b128 v[20:23], v3 offset:3072
    s_mov_b64 exec, s[16:17]
    ds_read_b128 v[24:27], v4 offset:2048
    ds_read_b128 v[28:31], v4 offset:2560
    s_mov_b64 exec, -1
    v_exp_f32 v64, v64
    v_exp_f32 v65, v65
    v_exp_f32 v66, v66
    v_exp_f32 v67, v67
    v_exp_f32 v68, v68
    v_exp_f32 v69, v69
    v_exp_f32 v70, v70
    v_exp_f32 v71, v71
    v_cvt_pk_bf16_f32 v40, v64, v65
    v_cvt_pk_bf16_f32 v41, v66, v67
    v_cvt_pk_bf16_f32 v42, v68, v69
    v_cvt_pk_bf16_f32 v43, v70, v71
    v_exp_f32 v72, v72
    v_exp_f32 v73, v73
    v_mfma_f32_32x32x16_bf16 v[96:111], v[32:35], v[40:43], v[96:111]
    v_exp_f32 v74, v74
    v_exp_f32 v75, v75
    v_exp_f32 v76, v76
    v_exp_f32 v77, v77
    v_exp_f32 v78, v78
    v_exp_f32 v79, v79
    v_cvt_pk_bf16_f32 v44, v72, v73
    v_cvt_pk_bf16_f32 v45, v74, v75
    v_cvt_pk_bf16_f32 v46, v76, v77
    v_cvt_pk_bf16_f32 v47, v78, v79
    s_nop 1
    v_mfma_f32_32x32x16_bf16 v[96:111], v[36:39], v[44:47], v[96:111]
    s_waitcnt lgkmcnt(0)
    v_mfma_f32_32x32x16_bf16 v[64:79], v[20:23], v[12:15], v[80:95]
    ds_read_b128 v[16:19], v3 offset:4096
    s_mov_b64 exec, s[16:17]
    ds_read_b128 v[32:35], v4 offset:3072
    ds_read_b128 v[36:39], v4 offset:3584
    s_mov_b64 exec, -1
    v_exp_f32 v48, v48
    v_exp_f32 v49, v49
    v_exp_f32 v50, v50
    v_exp_f32 v51, v51
    v_exp_f32 v52, v52
    v_exp_f32 v53, v53
    v_exp_f32 v54, v54
    v_exp_f32 v55, v55
    v_cvt_pk_bf16_f32 v40, v48, v49
    v_cvt_pk_bf16_f32 v41, v50, v51
    v_cvt_pk_bf16_f32 v42, v52, v53
    v_cvt_pk_bf16_f32 v43, v54, v55
    v_exp_f32 v56, v56
    v_exp_f32 v57, v57
    v_mfma_f32_32x32x16_bf16 v[96:111], v[24:27], v[40:43], v[96:111]
    v_exp_f32 v58, v58
    v_exp_f32 v59, v59
    v_exp_f32 v60, v60
    v_exp_f32 v61, v61
    v_exp_f32 v62, v62
    v_exp_f32 v63, v63
    v_cvt_pk_bf16_f32 v44, v56, v57
    v_cvt_pk_bf16_f32 v45, v58, v59
    v_cvt_pk_bf16_f32 v46, v60, v61
    v_cvt_pk_bf16_f32 v47, v62, v63
    s_nop 1
    v_mfma_f32_32x32x16_bf16 v[96:111], v[28:31], v[44:47], v[96:111]
    s_waitcnt lgkmcnt(0)
    v_mfma_f32_32x32x16_bf16 v[48:63], v[16:19], v[12:15], v[80:95]
    ds_read_b128 v[20:23], v3 offset:5120
    s_mov_b64 exec, s[16:17]
    ds_read_b128 v[24:27], v4 offset:4096
    ds_read_b128 v[28:31], v4 offset:4608
    s_mov_b64 exec, -1
    v_exp_f32 v64, v64
    v_exp_f32 v65, v65
    v_exp_f32 v66, v66
    v_exp_f32 v67, v67
    v_exp_f32 v68, v68
    v_exp_f32 v69, v69
    v_exp_f32 v70, v70
    v_exp_f32 v71, v71
    v_cvt_pk_bf16_f32 v40, v64, v65
    v_cvt_pk_bf16_f32 v41, v66, v67
    v_cvt_pk_bf16_f32 v42, v68, v69
    v_cvt_pk_bf16_f32 v43, v70, v71
    v_exp_f32 v72, v72
    v_exp_f32 v73, v73
    v_mfma_f32_32x32x16_bf16 v[96:111], v[32:35], v[40:43], v[96:111]
    v_exp_f32 v74, v74
    v_exp_f32 v75, v75
    v_exp_f32 v76, v76
    v_exp_f32 v77, v77
    v_exp_f32 v78, v78
    v_exp_f32 v79, v79
    v_cvt_pk_bf16_f32 v44, v72, v73
    v_cvt_pk_bf16_f32 v45, v74, v75
    v_cvt_pk_bf16_f32 v46, v76, v77
    v_cvt_pk_bf16_f32 v47, v78, v79
    s_nop 1
    v_mfma_f32_32x32x16_bf16 v[96:111], v[36:39], v[44:47], v[96:111]
    s_waitcnt lgkmcnt(0)
    v_mfma_f32_32x32x16_bf16 v[64:79], v[20:23], v[12:15], v[80:95]
    ds_read_b128 v[16:19], v3 offset:6144
    s_mov_b64 exec, s[16:17]
    ds_read_b128 v[32:35], v4 offset:5120
    ds_read_b128 v[36:39], v4 offset:5632
    s_mov_b64 exec, -1
    v_exp_f32 v48, v48
    v_exp_f32 v49, v49
    v_exp_f32 v50, v50
    v_exp_f32 v51, v51
    v_exp_f32 v52, v52
    v_exp_f32 v53, v53
    v_exp_f32 v54, v54
    v_exp_f32 v55, v55
    v_cvt_pk_bf16_f32 v40, v48, v49
    v_cvt_pk_bf16_f32 v41, v50, v51
    v_cvt_pk_bf16_f32 v42, v52, v53
    v_cvt_pk_bf16_f32 v43, v54, v55
    v_exp_f32 v56, v56
    v_exp_f32 v57, v57
    v_mfma_f32_32x32x16_bf16 v[96:111], v[24:27], v[40:43], v[96:111]
    v_exp_f32 v58, v58
    v_exp_f32 v59, v59
    v_exp_f32 v60, v60
    v_exp_f32 v61, v61
    v_exp_f32 v62, v62
    v_exp_f32 v63, v63
    v_cvt_pk_bf16_f32 v44, v56, v57
    v_cvt_pk_bf16_f32 v45, v58, v59
    v_cvt_pk_bf16_f32 v46, v60, v61
    v_cvt_pk_bf16_f32 v47, v62, v63
    s_nop 1
    v_mfma_f32_32x32x16_bf16 v[96:111], v[28:31], v[44:47], v[96:111]
    s_waitcnt vmcnt(10)
    s_barrier
    s_waitcnt lgkmcnt(0)
    v_mfma_f32_32x32x16_bf16 v[48:63], v[16:19], v[12:15], v[80:95]
    ds_read_b128 v[20:23], v3 offset:7168
    s_mov_b64 exec, s[16:17]
    ds_read_b128 v[24:27], v4 offset:6144
    ds_read_b128 v[28:31], v4 offset:6656
    s_mov_b64 exec, -1
    v_exp_f32 v64, v64
    v_exp_f32 v65, v65
    v_exp_f32 v66, v66
    v_exp_f32 v67, v67
    v_exp_f32 v68, v68
    v_exp_f32 v69, v69
    v_exp_f32 v70, v70
    v_exp_f32 v71, v71
    v_cvt_pk_bf16_f32 v40, v64, v65
    v_cvt_pk_bf16_f32 v41, v66, v67
    v_cvt_pk_bf16_f32 v42, v68, v69
    v_cvt_pk_bf16_f32 v43, v70, v71
    v_exp_f32 v72, v72
    v_exp_f32 v73, v73
    v_mfma_f32_32x32x16_bf16 v[96:111], v[32:35], v[40:43], v[96:111]
    v_exp_f32 v74, v74
    v_exp_f32 v75, v75
    v_exp_f32 v76, v76
    v_exp_f32 v77, v77
    v_exp_f32 v78, v78
    v_exp_f32 v79, v79
    v_cvt_pk_bf16_f32 v44, v72, v73
    v_cvt_pk_bf16_f32 v45, v74, v75
    v_cvt_pk_bf16_f32 v46, v76, v77
    v_cvt_pk_bf16_f32 v47, v78, v79
    s_nop 1
    v_mfma_f32_32x32x16_bf16 v[96:111], v[36:39], v[44:47], v[96:111]
    s_waitcnt lgkmcnt(0)
    v_mfma_f32_32x32x16_bf16 v[64:79], v[20:23], v[12:15], v[80:95]
    ds_read_b128 v[16:19], v3 offset:8192
    s_mov_b64 exec, s[16:17]
    ds_read_b128 v[32:35], v4 offset:7168
    ds_read_b128 v[36:39], v4 offset:7680
    s_mov_b64 exec, -1
    v_exp_f32 v48, v48
    v_exp_f32 v49, v49
    v_exp_f32 v50, v50
    v_exp_f32 v51, v51
    v_exp_f32 v52, v52
    v_exp_f32 v53, v53
    v_exp_f32 v54, v54
    v_exp_f32 v55, v55
    v_cvt_pk_bf16_f32 v40, v48, v49
    v_cvt_pk_bf16_f32 v41, v50, v51
    v_cvt_pk_bf16_f32 v42, v52, v53
    v_cvt_pk_bf16_f32 v43, v54, v55
    v_exp_f32 v56, v56
    v_exp_f32 v57, v57
    v_mfma_f32_32x32x16_bf16 v[96:111], v[24:27], v[40:43], v[96:111]
    v_exp_f32 v58, v58
    v_exp_f32 v59, v59
    v_exp_f32 v60, v60
    v_exp_f32 v61, v61
    v_exp_f32 v62, v62
    v_exp_f32 v63, v63
    v_cvt_pk_bf16_f32 v44, v56, v57
    v_cvt_pk_bf16_f32 v45, v58, v59
    v_cvt_pk_bf16_f32 v46, v60, v61
    v_cvt_pk_bf16_f32 v47, v62, v63
    s_nop 1
    v_mfma_f32_32x32x16_bf16 v[96:111], v[28:31], v[44:47], v[96:111]
    s_waitcnt lgkmcnt(0)
    v_mfma_f32_32x32x16_bf16 v[48:63], v[16:19], v[12:15], v[80:95]
    ds_read_b128 v[20:23], v3 offset:9216
    s_mov_b64 exec, s[16:17]
    ds_read_b128 v[24:27], v4 offset:8192
    ds_read_b128 v[28:31], v4 offset:8704
    s_mov_b64 exec, -1
    v_exp_f32 v64, v64
    v_exp_f32 v65, v65
    v_exp_f32 v66, v66
    v_exp_f32 v67, v67
    v_exp_f32 v68, v68
    v_exp_f32 v69, v69
    v_exp_f32 v70, v70
    v_exp_f32 v71, v71
    v_cvt_pk_bf16_f32 v40, v64, v65
    v_cvt_pk_bf16_f32 v41, v66, v67
    v_cvt_pk_bf16_f32 v42, v68, v69
    v_cvt_pk_bf16_f32 v43, v70, v71
    v_exp_f32 v72, v72
    v_exp_f32 v73, v73
    v_mfma_f32_32x32x16_bf16 v[96:111], v[32:35], v[40:43], v[96:111]
    v_exp_f32 v74, v74
    v_exp_f32 v75, v75
    v_exp_f32 v76, v76
    v_exp_f32 v77, v77
    v_exp_f32 v78, v78
    v_exp_f32 v79, v79
    v_cvt_pk_bf16_f32 v44, v72, v73
    v_cvt_pk_bf16_f32 v45, v74, v75
    v_cvt_pk_bf16_f32 v46, v76, v77
    v_cvt_pk_bf16_f32 v47, v78, v79
    s_nop 1
    v_mfma_f32_32x32x16_bf16 v[96:111], v[36:39], v[44:47], v[96:111]
    v_add_u32 v3, 8192, v3
    v_add_u32 v4, 8192, v4
    s_waitcnt lgkmcnt(0)
    v_mfma_f32_32x32x16_bf16 v[64:79], v[20:23], v[12:15], v[80:95]
    ds_read_b128 v[16:19], v3 offset:2048
    s_mov_b64 exec, s[16:17]
    ds_read_b128 v[32:35], v4 offset:1024
    ds_read_b128 v[36:39], v4 offset:1536
    s_mov_b64 exec, -1
    v_exp_f32 v48, v48
    v_exp_f32 v49, v49
    v_exp_f32 v50, v50
    v_exp_f32 v51, v51
    v_exp_f32 v52, v52
    v_exp_f32 v53, v53
    v_exp_f32 v54, v54
    v_exp_f32 v55, v55
    v_cvt_pk_bf16_f32 v40, v48, v49
    v_cvt_pk_bf16_f32 v41, v50, v51
    v_cvt_pk_bf16_f32 v42, v52, v53
    v_cvt_pk_bf16_f32 v43, v54, v55
    v_exp_f32 v56, v56
    v_exp_f32 v57, v57
    v_mfma_f32_32x32x16_bf16 v[96:111], v[24:27], v[40:43], v[96:111]
    v_exp_f32 v58, v58
    v_exp_f32 v59, v59
    v_exp_f32 v60, v60
    v_exp_f32 v61, v61
    v_exp_f32 v62, v62
    v_exp_f32 v63, v63
    v_cvt_pk_bf16_f32 v44, v56, v57
    v_cvt_pk_bf16_f32 v45, v58, v59
    v_cvt_pk_bf16_f32 v46, v60, v61
    v_cvt_pk_bf16_f32 v47, v62, v63
    s_nop 1
    v_mfma_f32_32x32x16_bf16 v[96:111], v[28:31], v[44:47], v[96:111]
    s_waitcnt lgkmcnt(0)
    v_mfma_f32_32x32x16_bf16 v[48:63], v[16:19], v[12:15], v[80:95]
    ds_read_b128 v[20:23], v3 offset:3072
    s_mov_b64 exec, s[16:17]
    ds_read_b128 v[24:27], v4 offset:2048
    ds_read_b128 v[28:31], v4 offset:2560
    s_mov_b64 exec, -1
    v_exp_f32 v64, v64
    v_exp_f32 v65, v65
    v_exp_f32 v66, v66
    v_exp_f32 v67, v67
    v_exp_f32 v68, v68
    v_exp_f32 v69, v69
    v_exp_f32 v70, v70
    v_exp_f32 v71, v71
    v_cvt_pk_bf16_f32 v40, v64, v65
    v_cvt_pk_bf16_f32 v41, v66, v67
    v_cvt_pk_bf16_f32 v42, v68, v69
    v_cvt_pk_bf16_f32 v43, v70, v71
    v_exp_f32 v72, v72
    v_exp_f32 v73, v73
    v_mfma_f32_32x32x16_bf16 v[96:111], v[32:35], v[40:43], v[96:111]
    v_exp_f32 v74, v74
    v_exp_f32 v75, v75
    v_exp_f32 v76, v76
    v_exp_f32 v77, v77
    v_exp_f32 v78, v78
    v_exp_f32 v79, v79
    v_cvt_pk_bf16_f32 v44, v72, v73
    v_cvt_pk_bf16_f32 v45, v74, v75
    v_cvt_pk_bf16_f32 v46, v76, v77
    v_cvt_pk_bf16_f32 v47, v78, v79
    s_nop 1
    v_mfma_f32_32x32x16_bf16 v[96:111], v[36:39], v[44:47], v[96:111]
    s_waitcnt lgkmcnt(0)
    v_mfma_f32_32x32x16_bf16 v[64:79], v[20:23], v[12:15], v[80:95]
    ds_read_b128 v[16:19], v3 offset:4096
    s_mov_b64 exec, s[16:17]
    ds_read_b128 v[32:35], v4 offset:3072
    ds_read_b128 v[36:39], v4 offset:3584
    s_mov_b64 exec, -1
    v_exp_f32 v48, v48
    v_exp_f32 v49, v49
    v_exp_f32 v50, v50
    v_exp_f32 v51, v51
    v_exp_f32 v52, v52
    v_exp_f32 v53, v53
    v_exp_f32 v54, v54
    v_exp_f32 v55, v55
    v_cvt_pk_bf16_f32 v40, v48, v49
    v_cvt_pk_bf16_f32 v41, v50, v51
    v_cvt_pk_bf16_f32 v42, v52, v53
    v_cvt_pk_bf16_f32 v43, v54, v55
    v_exp_f32 v56, v56
    v_exp_f32 v57, v57
    v_mfma_f32_32x32x16_bf16 v[96:111], v[24:27], v[40:43], v[96:111]
    v_exp_f32 v58, v58
    v_exp_f32 v59, v59
    v_exp_f32 v60, v60
    v_exp_f32 v61, v61
    v_exp_f32 v62, v62
    v_exp_f32 v63, v63
    v_cvt_pk_bf16_f32 v44, v56, v57
    v_cvt_pk_bf16_f32 v45, v58, v59
    v_cvt_pk_bf16_f32 v46, v60, v61
    v_cvt_pk_bf16_f32 v47, v62, v63
    s_nop 1
    v_mfma_f32_32x32x16_bf16 v[96:111], v[28:31], v[44:47], v[96:111]
    s_waitcnt lgkmcnt(0)
    v_mfma_f32_32x32x16_bf16 v[48:63], v[16:19], v[12:15], v[80:95]
    ds_read_b128 v[20:23], v3 offset:5120
    s_mov_b64 exec, s[16:17]
    ds_read_b128 v[24:27], v4 offset:4096
    ds_read_b128 v[28:31], v4 offset:4608
    s_mov_b64 exec, -1
    v_exp_f32 v64, v64
    v_exp_f32 v65, v65
    v_exp_f32 v66, v66
    v_exp_f32 v67, v67
    v_exp_f32 v68, v68
    v_exp_f32 v69, v69
    v_exp_f32 v70, v70
    v_exp_f32 v71, v71
    v_cvt_pk_bf16_f32 v40, v64, v65
    v_cvt_pk_bf16_f32 v41, v66, v67
    v_cvt_pk_bf16_f32 v42, v68, v69
    v_cvt_pk_bf16_f32 v43, v70, v71
    v_exp_f32 v72, v72
    v_exp_f32 v73, v73
    v_mfma_f32_32x32x16_bf16 v[96:111], v[32:35], v[40:43], v[96:111]
    v_exp_f32 v74, v74
    v_exp_f32 v75, v75
    v_exp_f32 v76, v76
    v_exp_f32 v77, v77
    v_exp_f32 v78, v78
    v_exp_f32 v79, v79
    v_cvt_pk_bf16_f32 v44, v72, v73
    v_cvt_pk_bf16_f32 v45, v74, v75
    v_cvt_pk_bf16_f32 v46, v76, v77
    v_cvt_pk_bf16_f32 v47, v78, v79
    s_nop 1
    v_mfma_f32_32x32x16_bf16 v[96:111], v[36:39], v[44:47], v[96:111]
    s_waitcnt lgkmcnt(0)
    v_mfma_f32_32x32x16_bf16 v[64:79], v[20:23], v[12:15], v[80:95]
    ds_read_b128 v[16:19], v3 offset:6144
    s_mov_b64 exec, s[16:17]
    ds_read_b128 v[32:35], v4 offset:5120
    ds_read_b128 v[36:39], v4 offset:5632
    s_mov_b64 exec, -1
    v_exp_f32 v48, v48
    v_exp_f32 v49, v49
    v_exp_f32 v50, v50
    v_exp_f32 v51, v51
    v_exp_f32 v52, v52
    v_exp_f32 v53, v53
    v_exp_f32 v54, v54
    v_exp_f32 v55, v55
    v_cvt_pk_bf16_f32 v40, v48, v49
    v_cvt_pk_bf16_f32 v41, v50, v51
    v_cvt_pk_bf16_f32 v42, v52, v53
    v_cvt_pk_bf16_f32 v43, v54, v55
    v_exp_f32 v56, v56
    v_exp_f32 v57, v57
    v_mfma_f32_32x32x16_bf16 v[96:111], v[24:27], v[40:43], v[96:111]
    v_exp_f32 v58, v58
    v_exp_f32 v59, v59
    v_exp_f32 v60, v60
    v_exp_f32 v61, v61
    v_exp_f32 v62, v62
    v_exp_f32 v63, v63
    v_cvt_pk_bf16_f32 v44, v56, v57
    v_cvt_pk_bf16_f32 v45, v58, v59
    v_cvt_pk_bf16_f32 v46, v60, v61
    v_cvt_pk_bf16_f32 v47, v62, v63
    s_nop 1
    v_mfma_f32_32x32x16_bf16 v[96:111], v[28:31], v[44:47], v[96:111]
    s_waitcnt lgkmcnt(0)
    v_mfma_f32_32x32x16_bf16 v[48:63], v[16:19], v[12:15], v[80:95]
    ds_read_b128 v[20:23], v3 offset:7168
    s_mov_b64 exec, s[16:17]
    ds_read_b128 v[24:27], v4 offset:6144
    ds_read_b128 v[28:31], v4 offset:6656
    s_mov_b64 exec, -1
    v_exp_f32 v64, v64
    v_exp_f32 v65, v65
    v_exp_f32 v66, v66
    v_exp_f32 v67, v67
    v_exp_f32 v68, v68
    v_exp_f32 v69, v69
    v_exp_f32 v70, v70
    v_exp_f32 v71, v71
    v_cvt_pk_bf16_f32 v40, v64, v65
    v_cvt_pk_bf16_f32 v41, v66, v67
    v_cvt_pk_bf16_f32 v42, v68, v69
    v_cvt_pk_bf16_f32 v43, v70, v71
    v_exp_f32 v72, v72
    v_exp_f32 v73, v73
    v_mfma_f32_32x32x16_bf16 v[96:111], v[32:35], v[40:43], v[96:111]
    v_exp_f32 v74, v74
    v_exp_f32 v75, v75
    v_exp_f32 v76, v76
    v_exp_f32 v77, v77
    v_exp_f32 v78, v78
    v_exp_f32 v79, v79
    v_cvt_pk_bf16_f32 v44, v72, v73
    v_cvt_pk_bf16_f32 v45, v74, v75
    v_cvt_pk_bf16_f32 v46, v76, v77
    v_cvt_pk_bf16_f32 v47, v78, v79
    s_nop 1
    v_mfma_f32_32x32x16_bf16 v[96:111], v[36:39], v[44:47], v[96:111]
    s_waitcnt lgkmcnt(0)
    v_mfma_f32_32x32x16_bf16 v[64:79], v[20:23], v[12:15], v[80:95]
    ds_read_b128 v[16:19], v3 offset:8192
    s_mov_b64 exec, s[16:17]
    ds_read_b128 v[32:35], v4 offset:7168
    ds_read_b128 v[36:39], v4 offset:7680
    s_mov_b64 exec, -1
    v_exp_f32 v48, v48
    v_exp_f32 v49, v49
    v_exp_f32 v50, v50
    v_exp_f32 v51, v51
    v_exp_f32 v52, v52
    v_exp_f32 v53, v53
    v_exp_f32 v54, v54
    v_exp_f32 v55, v55
    v_cvt_pk_bf16_f32 v40, v48, v49
    v_cvt_pk_bf16_f32 v41, v50, v51
    v_cvt_pk_bf16_f32 v42, v52, v53
    v_cvt_pk_bf16_f32 v43, v54, v55
    v_exp_f32 v56, v56
    v_exp_f32 v57, v57
    v_mfma_f32_32x32x16_bf16 v[96:111], v[24:27], v[40:43], v[96:111]
    v_exp_f32 v58, v58
    v_exp_f32 v59, v59
    v_exp_f32 v60, v60
    v_exp_f32 v61, v61
    v_exp_f32 v62, v62
    v_exp_f32 v63, v63
    v_cvt_pk_bf16_f32 v44, v56, v57
    v_cvt_pk_bf16_f32 v45, v58, v59
    v_cvt_pk_bf16_f32 v46, v60, v61
    v_cvt_pk_bf16_f32 v47, v62, v63
    s_nop 1
    v_mfma_f32_32x32x16_bf16 v[96:111], v[28:31], v[44:47], v[96:111]
    s_waitcnt lgkmcnt(0)
    v_mfma_f32_32x32x16_bf16 v[48:63], v[16:19], v[12:15], v[80:95]
    ds_read_b128 v[20:23], v3 offset:9216
    s_mov_b64 exec, s[16:17]
    ds_read_b128 v[24:27], v4 offset:8192
    ds_read_b128 v[28:31], v4 offset:8704
    s_mov_b64 exec, -1
    v_exp_f32 v64, v64
    v_exp_f32 v65, v65
    v_exp_f32 v66, v66
    v_exp_f32 v67, v67
    v_exp_f32 v68, v68
    v_exp_f32 v69, v69
    v_exp_f32 v70, v70
    v_exp_f32 v71, v71
    v_cvt_pk_bf16_f32 v40, v64, v65
    v_cvt_pk_bf16_f32 v41, v66, v67
    v_cvt_pk_bf16_f32 v42, v68, v69
    v_cvt_pk_bf16_f32 v43, v70, v71
    v_exp_f32 v72, v72
    v_exp_f32 v73, v73
    v_mfma_f32_32x32x16_bf16 v[96:111], v[32:35], v[40:43], v[96:111]
    v_exp_f32 v74, v74
    v_exp_f32 v75, v75
    v_exp_f32 v76, v76
    v_exp_f32 v77, v77
    v_exp_f32 v78, v78
    v_exp_f32 v79, v79
    v_cvt_pk_bf16_f32 v44, v72, v73
    v_cvt_pk_bf16_f32 v45, v74, v75
    v_cvt_pk_bf16_f32 v46, v76, v77
    v_cvt_pk_bf16_f32 v47, v78, v79
    s_nop 1
    v_mfma_f32_32x32x16_bf16 v[96:111], v[36:39], v[44:47], v[96:111]
    v_add_u32 v3, 8192, v3
    v_add_u32 v4, 8192, v4
    s_waitcnt lgkmcnt(0)
    v_mfma_f32_32x32x16_bf16 v[64:79], v[20:23], v[12:15], v[80:95]
    ds_read_b128 v[16:19], v3 offset:2048
    s_mov_b64 exec, s[16:17]
    ds_read_b128 v[32:35], v4 offset:1024
    ds_read_b128 v[36:39], v4 offset:1536
    s_mov_b64 exec, -1
    v_exp_f32 v48, v48
    v_exp_f32 v49, v49
    v_exp_f32 v50, v50
    v_exp_f32 v51, v51
    v_exp_f32 v52, v52
    v_exp_f32 v53, v53
    v_exp_f32 v54, v54
    v_exp_f32 v55, v55
    v_cvt_pk_bf16_f32 v40, v48, v49
    v_cvt_pk_bf16_f32 v41, v50, v51
    v_cvt_pk_bf16_f32 v42, v52, v53
    v_cvt_pk_bf16_f32 v43, v54, v55
    v_exp_f32 v56, v56
    v_exp_f32 v57, v57
    v_mfma_f32_32x32x16_bf16 v[96:111], v[24:27], v[40:43], v[96:111]
    v_exp_f32 v58, v58
    v_exp_f32 v59, v59
    v_exp_f32 v60, v60
    v_exp_f32 v61, v61
    v_exp_f32 v62, v62
    v_exp_f32 v63, v63
    v_cvt_pk_bf16_f32 v44, v56, v57
    v_cvt_pk_bf16_f32 v45, v58, v59
    v_cvt_pk_bf16_f32 v46, v60, v61
    v_cvt_pk_bf16_f32 v47, v62, v63
    s_nop 1
    v_mfma_f32_32x32x16_bf16 v[96:111], v[28:31], v[44:47], v[96:111]
    s_waitcnt lgkmcnt(0)
    v_mfma_f32_32x32x16_bf16 v[48:63], v[16:19], v[12:15], v[80:95]
    ds_read_b128 v[20:23], v3 offset:3072
    s_mov_b64 exec, s[16:17]
    ds_read_b128 v[24:27], v4 offset:2048
    ds_read_b128 v[28:31], v4 offset:2560
    s_mov_b64 exec, -1
    v_exp_f32 v64, v64
    v_exp_f32 v65, v65
    v_exp_f32 v66, v66
    v_exp_f32 v67, v67
    v_exp_f32 v68, v68
    v_exp_f32 v69, v69
    v_exp_f32 v70, v70
    v_exp_f32 v71, v71
    v_cvt_pk_bf16_f32 v40, v64, v65
    v_cvt_pk_bf16_f32 v41, v66, v67
    v_cvt_pk_bf16_f32 v42, v68, v69
    v_cvt_pk_bf16_f32 v43, v70, v71
    v_exp_f32 v72, v72
    v_exp_f32 v73, v73
    v_mfma_f32_32x32x16_bf16 v[96:111], v[32:35], v[40:43], v[96:111]
    v_exp_f32 v74, v74
    v_exp_f32 v75, v75
    v_exp_f32 v76, v76
    v_exp_f32 v77, v77
    v_exp_f32 v78, v78
    v_exp_f32 v79, v79
    v_cvt_pk_bf16_f32 v44, v72, v73
    v_cvt_pk_bf16_f32 v45, v74, v75
    v_cvt_pk_bf16_f32 v46, v76, v77
    v_cvt_pk_bf16_f32 v47, v78, v79
    s_nop 1
    v_mfma_f32_32x32x16_bf16 v[96:111], v[36:39], v[44:47], v[96:111]
    s_waitcnt lgkmcnt(0)
    v_mfma_f32_32x32x16_bf16 v[64:79], v[20:23], v[12:15], v[80:95]
    ds_read_b128 v[16:19], v3 offset:4096
    s_mov_b64 exec, s[16:17]
    ds_read_b128 v[32:35], v4 offset:3072
    ds_read_b128 v[36:39], v4 offset:3584
    s_mov_b64 exec, -1
    v_exp_f32 v48, v48
    v_exp_f32 v49, v49
    v_exp_f32 v50, v50
    v_exp_f32 v51, v51
    v_exp_f32 v52, v52
    v_exp_f32 v53, v53
    v_exp_f32 v54, v54
    v_exp_f32 v55, v55
    v_cvt_pk_bf16_f32 v40, v48, v49
    v_cvt_pk_bf16_f32 v41, v50, v51
    v_cvt_pk_bf16_f32 v42, v52, v53
    v_cvt_pk_bf16_f32 v43, v54, v55
    v_exp_f32 v56, v56
    v_exp_f32 v57, v57
    v_mfma_f32_32x32x16_bf16 v[96:111], v[24:27], v[40:43], v[96:111]
    v_exp_f32 v58, v58
    v_exp_f32 v59, v59
    v_exp_f32 v60, v60
    v_exp_f32 v61, v61
    v_exp_f32 v62, v62
    v_exp_f32 v63, v63
    v_cvt_pk_bf16_f32 v44, v56, v57
    v_cvt_pk_bf16_f32 v45, v58, v59
    v_cvt_pk_bf16_f32 v46, v60, v61
    v_cvt_pk_bf16_f32 v47, v62, v63
    s_nop 1
    v_mfma_f32_32x32x16_bf16 v[96:111], v[28:31], v[44:47], v[96:111]
    s_waitcnt lgkmcnt(0)
    v_mfma_f32_32x32x16_bf16 v[48:63], v[16:19], v[12:15], v[80:95]
    ds_read_b128 v[20:23], v3 offset:5120
    s_mov_b64 exec, s[16:17]
    ds_read_b128 v[24:27], v4 offset:4096
    ds_read_b128 v[28:31], v4 offset:4608
    s_mov_b64 exec, -1
    v_exp_f32 v64, v64
    v_exp_f32 v65, v65
    v_exp_f32 v66, v66
    v_exp_f32 v67, v67
    v_exp_f32 v68, v68
    v_exp_f32 v69, v69
    v_exp_f32 v70, v70
    v_exp_f32 v71, v71
    v_cvt_pk_bf16_f32 v40, v64, v65
    v_cvt_pk_bf16_f32 v41, v66, v67
    v_cvt_pk_bf16_f32 v42, v68, v69
    v_cvt_pk_bf16_f32 v43, v70, v71
    v_exp_f32 v72, v72
    v_exp_f32 v73, v73
    v_mfma_f32_32x32x16_bf16 v[96:111], v[32:35], v[40:43], v[96:111]
    v_exp_f32 v74, v74
    v_exp_f32 v75, v75
    v_exp_f32 v76, v76
    v_exp_f32 v77, v77
    v_exp_f32 v78, v78
    v_exp_f32 v79, v79
    v_cvt_pk_bf16_f32 v44, v72, v73
    v_cvt_pk_bf16_f32 v45, v74, v75
    v_cvt_pk_bf16_f32 v46, v76, v77
    v_cvt_pk_bf16_f32 v47, v78, v79
    s_nop 1
    v_mfma_f32_32x32x16_bf16 v[96:111], v[36:39], v[44:47], v[96:111]
    s_waitcnt lgkmcnt(0)
    v_mfma_f32_32x32x16_bf16 v[64:79], v[20:23], v[12:15], v[80:95]
    ds_read_b128 v[16:19], v3 offset:6144
    s_mov_b64 exec, s[16:17]
    ds_read_b128 v[32:35], v4 offset:5120
    ds_read_b128 v[36:39], v4 offset:5632
    s_mov_b64 exec, -1
    v_exp_f32 v48, v48
    v_exp_f32 v49, v49
    v_exp_f32 v50, v50
    v_exp_f32 v51, v51
    v_exp_f32 v52, v52
    v_exp_f32 v53, v53
    v_exp_f32 v54, v54
    v_exp_f32 v55, v55
    v_cvt_pk_bf16_f32 v40, v48, v49
    v_cvt_pk_bf16_f32 v41, v50, v51
    v_cvt_pk_bf16_f32 v42, v52, v53
    v_cvt_pk_bf16_f32 v43, v54, v55
    v_exp_f32 v56, v56
    v_exp_f32 v57, v57
    v_mfma_f32_32x32x16_bf16 v[96:111], v[24:27], v[40:43], v[96:111]
    v_exp_f32 v58, v58
    v_exp_f32 v59, v59
    v_exp_f32 v60, v60
    v_exp_f32 v61, v61
    v_exp_f32 v62, v62
    v_exp_f32 v63, v63
    v_cvt_pk_bf16_f32 v44, v56, v57
    v_cvt_pk_bf16_f32 v45, v58, v59
    v_cvt_pk_bf16_f32 v46, v60, v61
    v_cvt_pk_bf16_f32 v47, v62, v63
    s_nop 1
    v_mfma_f32_32x32x16_bf16 v[96:111], v[28:31], v[44:47], v[96:111]
    s_waitcnt vmcnt(0)
    s_barrier
    s_waitcnt lgkmcnt(0)
    v_mfma_f32_32x32x16_bf16 v[48:63], v[16:19], v[12:15], v[80:95]
    ds_read_b128 v[20:23], v3 offset:7168
    s_mov_b64 exec, s[16:17]
    ds_read_b128 v[24:27], v4 offset:6144
    ds_read_b128 v[28:31], v4 offset:6656
    s_mov_b64 exec, -1
    v_exp_f32 v64, v64
    v_exp_f32 v65, v65
    v_exp_f32 v66, v66
    v_exp_f32 v67, v67
    v_exp_f32 v68, v68
    v_exp_f32 v69, v69
    v_exp_f32 v70, v70
    v_exp_f32 v71, v71
    v_cvt_pk_bf16_f32 v40, v64, v65
    v_cvt_pk_bf16_f32 v41, v66, v67
    v_cvt_pk_bf16_f32 v42, v68, v69
    v_cvt_pk_bf16_f32 v43, v70, v71
    v_exp_f32 v72, v72
    v_exp_f32 v73, v73
    v_mfma_f32_32x32x16_bf16 v[96:111], v[32:35], v[40:43], v[96:111]
    v_exp_f32 v74, v74
    v_exp_f32 v75, v75
    v_exp_f32 v76, v76
    v_exp_f32 v77, v77
    v_exp_f32 v78, v78
    v_exp_f32 v79, v79
    v_cvt_pk_bf16_f32 v44, v72, v73
    v_cvt_pk_bf16_f32 v45, v74, v75
    v_cvt_pk_bf16_f32 v46, v76, v77
    v_cvt_pk_bf16_f32 v47, v78, v79
    s_nop 1
    v_mfma_f32_32x32x16_bf16 v[96:111], v[36:39], v[44:47], v[96:111]
    s_waitcnt lgkmcnt(0)
    v_mfma_f32_32x32x16_bf16 v[64:79], v[20:23], v[12:15], v[80:95]
    ds_read_b128 v[16:19], v3 offset:8192
    s_mov_b64 exec, s[16:17]
    ds_read_b128 v[32:35], v4 offset:7168
    ds_read_b128 v[36:39], v4 offset:7680
    s_mov_b64 exec, -1
    v_exp_f32 v48, v48
    v_exp_f32 v49, v49
    v_exp_f32 v50, v50
    v_exp_f32 v51, v51
    v_exp_f32 v52, v52
    v_exp_f32 v53, v53
    v_exp_f32 v54, v54
    v_exp_f32 v55, v55
    v_cvt_pk_bf16_f32 v40, v48, v49
    v_cvt_pk_bf16_f32 v41, v50, v51
    v_cvt_pk_bf16_f32 v42, v52, v53
    v_cvt_pk_bf16_f32 v43, v54, v55
    v_exp_f32 v56, v56
    v_exp_f32 v57, v57
    v_mfma_f32_32x32x16_bf16 v[96:111], v[24:27], v[40:43], v[96:111]
    v_exp_f32 v58, v58
    v_exp_f32 v59, v59
    v_exp_f32 v60, v60
    v_exp_f32 v61, v61
    v_exp_f32 v62, v62
    v_exp_f32 v63, v63
    v_cvt_pk_bf16_f32 v44, v56, v57
    v_cvt_pk_bf16_f32 v45, v58, v59
    v_cvt_pk_bf16_f32 v46, v60, v61
    v_cvt_pk_bf16_f32 v47, v62, v63
    s_nop 1
    v_mfma_f32_32x32x16_bf16 v[96:111], v[28:31], v[44:47], v[96:111]
    s_waitcnt lgkmcnt(0)
    v_mfma_f32_32x32x16_bf16 v[48:63], v[16:19], v[12:15], v[80:95]
    ds_read_b128 v[20:23], v3 offset:9216
    s_mov_b64 exec, s[16:17]
    ds_read_b128 v[24:27], v4 offset:8192
    ds_read_b128 v[28:31], v4 offset:8704
    s_mov_b64 exec, -1
    v_exp_f32 v64, v64
    v_exp_f32 v65, v65
    v_exp_f32 v66, v66
    v_exp_f32 v67, v67
    v_exp_f32 v68, v68
    v_exp_f32 v69, v69
    v_exp_f32 v70, v70
    v_exp_f32 v71, v71
    v_cvt_pk_bf16_f32 v40, v64, v65
    v_cvt_pk_bf16_f32 v41, v66, v67
    v_cvt_pk_bf16_f32 v42, v68, v69
    v_cvt_pk_bf16_f32 v43, v70, v71
    v_exp_f32 v72, v72
    v_exp_f32 v73, v73
    v_mfma_f32_32x32x16_bf16 v[96:111], v[32:35], v[40:43], v[96:111]
    v_exp_f32 v74, v74
    v_exp_f32 v75, v75
    v_exp_f32 v76, v76
    v_exp_f32 v77, v77
    v_exp_f32 v78, v78
    v_exp_f32 v79, v79
    v_cvt_pk_bf16_f32 v44, v72, v73
    v_cvt_pk_bf16_f32 v45, v74, v75
    v_cvt_pk_bf16_f32 v46, v76, v77
    v_cvt_pk_bf16_f32 v47, v78, v79
    s_nop 1
    v_mfma_f32_32x32x16_bf16 v[96:111], v[36:39], v[44:47], v[96:111]
    v_add_u32 v3, 8192, v3
    v_add_u32 v4, 8192, v4
    s_mov_b32 s18, 5
k2_kernel_aloop:
    s_waitcnt lgkmcnt(0)
    v_mfma_f32_32x32x16_bf16 v[64:79], v[20:23], v[12:15], v[80:95]
    ds_read_b128 v[16:19], v3 offset:2048
    s_mov_b64 exec, s[16:17]
    ds_read_b128 v[32:35], v4 offset:1024
    ds_read_b128 v[36:39], v4 offset:1536
    s_mov_b64 exec, -1
    v_exp_f32 v48, v48
    v_exp_f32 v49, v49
    v_exp_f32 v50, v50
    v_exp_f32 v51, v51
    v_exp_f32 v52, v52
    v_exp_f32 v53, v53
    v_exp_f32 v54, v54
    v_exp_f32 v55, v55
    v_cvt_pk_bf16_f32 v40, v48, v49
    v_cvt_pk_bf16_f32 v41, v50, v51
    v_cvt_pk_bf16_f32 v42, v52, v53
    v_cvt_pk_bf16_f32 v43, v54, v55
    v_exp_f32 v56, v56
    v_exp_f32 v57, v57
    v_mfma_f32_32x32x16_bf16 v[96:111], v[24:27], v[40:43], v[96:111]
    v_exp_f32 v58, v58
    v_exp_f32 v59, v59
    v_exp_f32 v60, v60
    v_exp_f32 v61, v61
    v_exp_f32 v62, v62
    v_exp_f32 v63, v63
    v_cvt_pk_bf16_f32 v44, v56, v57
    v_cvt_pk_bf16_f32 v45, v58, v59
    v_cvt_pk_bf16_f32 v46, v60, v61
    v_cvt_pk_bf16_f32 v47, v62, v63
    s_nop 1
    v_mfma_f32_32x32x16_bf16 v[96:111], v[28:31], v[44:47], v[96:111]
    s_waitcnt lgkmcnt(0)
    v_mfma_f32_32x32x16_bf16 v[48:63], v[16:19], v[12:15], v[80:95]
    ds_read_b128 v[20:23], v3 offset:3072
    s_mov_b64 exec, s[16:17]
    ds_read_b128 v[24:27], v4 offset:2048
    ds_read_b128 v[28:31], v4 offset:2560
    s_mov_b64 exec, -1
    v_exp_f32 v64, v64
    v_exp_f32 v65, v65
    v_exp_f32 v66, v66
    v_exp_f32 v67, v67
    v_exp_f32 v68, v68
    v_exp_f32 v69, v69
    v_exp_f32 v70, v70
    v_exp_f32 v71, v71
    v_cvt_pk_bf16_f32 v40, v64, v65
    v_cvt_pk_bf16_f32 v41, v66, v67
    v_cvt_pk_bf16_f32 v42, v68, v69
    v_cvt_pk_bf16_f32 v43, v70, v71
    v_exp_f32 v72, v72
    v_exp_f32 v73, v73
    v_mfma_f32_32x32x16_bf16 v[96:111], v[32:35], v[40:43], v[96:111]
    v_exp_f32 v74, v74
    v_exp_f32 v75, v75
    v_exp_f32 v76, v76
    v_exp_f32 v77, v77
    v_exp_f32 v78, v78
    v_exp_f32 v79, v79
    v_cvt_pk_bf16_f32 v44, v72, v73
    v_cvt_pk_bf16_f32 v45, v74, v75
    v_cvt_pk_bf16_f32 v46, v76, v77
    v_cvt_pk_bf16_f32 v47, v78, v79
    s_nop 1
    v_mfma_f32_32x32x16_bf16 v[96:111], v[36:39], v[44:47], v[96:111]
    s_waitcnt lgkmcnt(0)
    v_mfma_f32_32x32x16_bf16 v[64:79], v[20:23], v[12:15], v[80:95]
    ds_read_b128 v[16:19], v3 offset:4096
    s_mov_b64 exec, s[16:17]
    ds_read_b128 v[32:35], v4 offset:3072
    ds_read_b128 v[36:39], v4 offset:3584
    s_mov_b64 exec, -1
    v_exp_f32 v48, v48
    v_exp_f32 v49, v49
    v_exp_f32 v50, v50
    v_exp_f32 v51, v51
    v_exp_f32 v52, v52
    v_exp_f32 v53, v53
    v_exp_f32 v54, v54
    v_exp_f32 v55, v55
    v_cvt_pk_bf16_f32 v40, v48, v49
    v_cvt_pk_bf16_f32 v41, v50, v51
    v_cvt_pk_bf16_f32 v42, v52, v53
    v_cvt_pk_bf16_f32 v43, v54, v55
    v_exp_f32 v56, v56
    v_exp_f32 v57, v57
    v_mfma_f32_32x32x16_bf16 v[96:111], v[24:27], v[40:43], v[96:111]
    v_exp_f32 v58, v58
    v_exp_f32 v59, v59
    v_exp_f32 v60, v60
    v_exp_f32 v61, v61
    v_exp_f32 v62, v62
    v_exp_f32 v63, v63
    v_cvt_pk_bf16_f32 v44, v56, v57
    v_cvt_pk_bf16_f32 v45, v58, v59
    v_cvt_pk_bf16_f32 v46, v60, v61
    v_cvt_pk_bf16_f32 v47, v62, v63
    s_nop 1
    v_mfma_f32_32x32x16_bf16 v[96:111], v[28:31], v[44:47], v[96:111]
    s_waitcnt lgkmcnt(0)
    v_mfma_f32_32x32x16_bf16 v[48:63], v[16:19], v[12:15], v[80:95]
    ds_read_b128 v[20:23], v3 offset:5120
    s_mov_b64 exec, s[16:17]
    ds_read_b128 v[24:27], v4 offset:4096
    ds_read_b128 v[28:31], v4 offset:4608
    s_mov_b64 exec, -1
    v_exp_f32 v64, v64
    v_exp_f32 v65, v65
    v_exp_f32 v66, v66
    v_exp_f32 v67, v67
    v_exp_f32 v68, v68
    v_exp_f32 v69, v69
    v_exp_f32 v70, v70
    v_exp_f32 v71, v71
    v_cvt_pk_bf16_f32 v40, v64, v65
    v_cvt_pk_bf16_f32 v41, v66, v67
    v_cvt_pk_bf16_f32 v42, v68, v69
    v_cvt_pk_bf16_f32 v43, v70, v71
    v_exp_f32 v72, v72
    v_exp_f32 v73, v73
    v_mfma_f32_32x32x16_bf16 v[96:111], v[32:35], v[40:43], v[96:111]
    v_exp_f32 v74, v74
    v_exp_f32 v75, v75
    v_exp_f32 v76, v76
    v_exp_f32 v77, v77
    v_exp_f32 v78, v78
    v_exp_f32 v79, v79
    v_cvt_pk_bf16_f32 v44, v72, v73
    v_cvt_pk_bf16_f32 v45, v74, v75
    v_cvt_pk_bf16_f32 v46, v76, v77
    v_cvt_pk_bf16_f32 v47, v78, v79
    s_nop 1
    v_mfma_f32_32x32x16_bf16 v[96:111], v[36:39], v[44:47], v[96:111]
    s_waitcnt lgkmcnt(0)
    v_mfma_f32_32x32x16_bf16 v[64:79], v[20:23], v[12:15], v[80:95]
    ds_read_b128 v[16:19], v3 offset:6144
    s_mov_b64 exec, s[16:17]
    ds_read_b128 v[32:35], v4 offset:5120
    ds_read_b128 v[36:39], v4 offset:5632
    s_mov_b64 exec, -1
    v_exp_f32 v48, v48
    v_exp_f32 v49, v49
    v_exp_f32 v50, v50
    v_exp_f32 v51, v51
    v_exp_f32 v52, v52
    v_exp_f32 v53, v53
    v_exp_f32 v54, v54
    v_exp_f32 v55, v55
    v_cvt_pk_bf16_f32 v40, v48, v49
    v_cvt_pk_bf16_f32 v41, v50, v51
    v_cvt_pk_bf16_f32 v42, v52, v53
    v_cvt_pk_bf16_f32 v43, v54, v55
    v_exp_f32 v56, v56
    v_exp_f32 v57, v57
    v_mfma_f32_32x32x16_bf16 v[96:111], v[24:27], v[40:43], v[96:111]
    v_exp_f32 v58, v58
    v_exp_f32 v59, v59
    v_exp_f32 v60, v60
    v_exp_f32 v61, v61
    v_exp_f32 v62, v62
    v_exp_f32 v63, v63
    v_cvt_pk_bf16_f32 v44, v56, v57
    v_cvt_pk_bf16_f32 v45, v58, v59
    v_cvt_pk_bf16_f32 v46, v60, v61
    v_cvt_pk_bf16_f32 v47, v62, v63
    s_nop 1
    v_mfma_f32_32x32x16_bf16 v[96:111], v[28:31], v[44:47], v[96:111]
    s_waitcnt lgkmcnt(0)
    v_mfma_f32_32x32x16_bf16 v[48:63], v[16:19], v[12:15], v[80:95]
    ds_read_b128 v[20:23], v3 offset:7168
    s_mov_b64 exec, s[16:17]
    ds_read_b128 v[24:27], v4 offset:6144
    ds_read_b128 v[28:31], v4 offset:6656
    s_mov_b64 exec, -1
    v_exp_f32 v64, v64
    v_exp_f32 v65, v65
    v_exp_f32 v66, v66
    v_exp_f32 v67, v67
    v_exp_f32 v68, v68
    v_exp_f32 v69, v69
    v_exp_f32 v70, v70
    v_exp_f32 v71, v71
    v_cvt_pk_bf16_f32 v40, v64, v65
    v_cvt_pk_bf16_f32 v41, v66, v67
    v_cvt_pk_bf16_f32 v42, v68, v69
    v_cvt_pk_bf16_f32 v43, v70, v71
    v_exp_f32 v72, v72
    v_exp_f32 v73, v73
    v_mfma_f32_32x32x16_bf16 v[96:111], v[32:35], v[40:43], v[96:111]
    v_exp_f32 v74, v74
    v_exp_f32 v75, v75
    v_exp_f32 v76, v76
    v_exp_f32 v77, v77
    v_exp_f32 v78, v78
    v_exp_f32 v79, v79
    v_cvt_pk_bf16_f32 v44, v72, v73
    v_cvt_pk_bf16_f32 v45, v74, v75
    v_cvt_pk_bf16_f32 v46, v76, v77
    v_cvt_pk_bf16_f32 v47, v78, v79
    s_nop 1
    v_mfma_f32_32x32x16_bf16 v[96:111], v[36:39], v[44:47], v[96:111]
    s_waitcnt lgkmcnt(0)
    v_mfma_f32_32x32x16_bf16 v[64:79], v[20:23], v[12:15], v[80:95]
    ds_read_b128 v[16:19], v3 offset:8192
    s_mov_b64 exec, s[16:17]
    ds_read_b128 v[32:35], v4 offset:7168
    ds_read_b128 v[36:39], v4 offset:7680
    s_mov_b64 exec, -1
    v_exp_f32 v48, v48
    v_exp_f32 v49, v49
    v_exp_f32 v50, v50
    v_exp_f32 v51, v51
    v_exp_f32 v52, v52
    v_exp_f32 v53, v53
    v_exp_f32 v54, v54
    v_exp_f32 v55, v55
    v_cvt_pk_bf16_f32 v40, v48, v49
    v_cvt_pk_bf16_f32 v41, v50, v51
    v_cvt_pk_bf16_f32 v42, v52, v53
    v_cvt_pk_bf16_f32 v43, v54, v55
    v_exp_f32 v56, v56
    v_exp_f32 v57, v57
    v_mfma_f32_32x32x16_bf16 v[96:111], v[24:27], v[40:43], v[96:111]
    v_exp_f32 v58, v58
    v_exp_f32 v59, v59
    v_exp_f32 v60, v60
    v_exp_f32 v61, v61
    v_exp_f32 v62, v62
    v_exp_f32 v63, v63
    v_cvt_pk_bf16_f32 v44, v56, v57
    v_cvt_pk_bf16_f32 v45, v58, v59
    v_cvt_pk_bf16_f32 v46, v60, v61
    v_cvt_pk_bf16_f32 v47, v62, v63
    s_nop 1
    v_mfma_f32_32x32x16_bf16 v[96:111], v[28:31], v[44:47], v[96:111]
    s_waitcnt lgkmcnt(0)
    v_mfma_f32_32x32x16_bf16 v[48:63], v[16:19], v[12:15], v[80:95]
    ds_read_b128 v[20:23], v3 offset:9216
    s_mov_b64 exec, s[16:17]
    ds_read_b128 v[24:27], v4 offset:8192
    ds_read_b128 v[28:31], v4 offset:8704
    s_mov_b64 exec, -1
    v_exp_f32 v64, v64
    v_exp_f32 v65, v65
    v_exp_f32 v66, v66
    v_exp_f32 v67, v67
    v_exp_f32 v68, v68
    v_exp_f32 v69, v69
    v_exp_f32 v70, v70
    v_exp_f32 v71, v71
    v_cvt_pk_bf16_f32 v40, v64, v65
    v_cvt_pk_bf16_f32 v41, v66, v67
    v_cvt_pk_bf16_f32 v42, v68, v69
    v_cvt_pk_bf16_f32 v43, v70, v71
    v_exp_f32 v72, v72
    v_exp_f32 v73, v73
    v_mfma_f32_32x32x16_bf16 v[96:111], v[32:35], v[40:43], v[96:111]
    v_exp_f32 v74, v74
    v_exp_f32 v75, v75
    v_exp_f32 v76, v76
    v_exp_f32 v77, v77
    v_exp_f32 v78, v78
    v_exp_f32 v79, v79
    v_cvt_pk_bf16_f32 v44, v72, v73
    v_cvt_pk_bf16_f32 v45, v74, v75
    v_cvt_pk_bf16_f32 v46, v76, v77
    v_cvt_pk_bf16_f32 v47, v78, v79
    s_nop 1
    v_mfma_f32_32x32x16_bf16 v[96:111], v[36:39], v[44:47], v[96:111]
    v_add_u32 v3, 8192, v3
    v_add_u32 v4, 8192, v4
    s_sub_u32 s18, s18, 1
    s_cmp_lg_u32 s18, 0
    s_cbranch_scc1 k2_kernel_aloop
    s_nop 7
    s_nop 7
    v_mov_b32 v5, 0x71800000
    v_cmp_lt_f32 vcc, v104, v5
    s_nop 1
    s_cmp_eq_u64 vcc, -1
    s_cbranch_scc0 k2_kernel_slow
k2_kernel_fin:
    v_rcp_f32 v5, v104
    s_nop 0
    v_mul_f32 v96, v96, v5
    v_mul_f32 v97, v97, v5
    v_mul_f32 v98, v98, v5
    v_mul_f32 v99, v99, v5
    v_mul_f32 v100, v100, v5
    v_mul_f32 v101, v101, v5
    v_mul_f32 v102, v102, v5
    v_mul_f32 v103, v103, v5
    v_cvt_pk_bf16_f32 v40, v96, v97
    v_cvt_pk_bf16_f32 v41, v98, v99
    v_cvt_pk_bf16_f32 v42, v100, v101
    v_cvt_pk_bf16_f32 v43, v102, v103
    buffer_store_dwordx4 v[40:43], v2, s[8:11], s19 offen sc1
    s_endpgm
k2_kernel_slow:
    v_mov_b32 v3, v2
    v_add_u32 v4, 4294901760, v4
    v_mov_b32 v5, 0xff61b1e6
    v_mov_b32 v96, 0
    v_mov_b32 v97, 0
    v_mov_b32 v98, 0
    v_mov_b32 v99, 0
    v_mov_b32 v100, 0
    v_mov_b32 v101, 0
    v_mov_b32 v102, 0
    v_mov_b32 v103, 0
    v_mov_b32 v104, 0
    v_mov_b32 v105, 0
    v_mov_b32 v106, 0
    v_mov_b32 v107, 0
    v_mov_b32 v108, 0
    v_mov_b32 v109, 0
    v_mov_b32 v110, 0
    v_mov_b32 v111, 0
    s_mov_b32 s18, 64
k2_kernel_sloop:
    ds_read_b128 v[16:19], v3
    s_mov_b64 exec, s[16:17]
    ds_read_b128 v[24:27], v4
    ds_read_b128 v[28:31], v4 offset:512
    s_mov_b64 exec, -1
    s_waitcnt lgkmcnt(0)
    v_mfma_f32_32x32x16_bf16 v[48:63], v[16:19], v[12:15], 0
    s_nop 7
    s_nop 7
    v_mov_b32 v6, v5
    v_max3_f32 v6, v48, v49, v6
    v_max3_f32 v6, v50, v51, v6
    v_max3_f32 v6, v52, v53, v6
    v_max3_f32 v6, v54, v55, v6
    v_max3_f32 v6, v56, v57, v6
    v_max3_f32 v6, v58, v59, v6
    v_max3_f32 v6, v60, v61, v6
    v_max3_f32 v6, v62, v63, v6
    s_nop 0
    v_mov_b32 v7, v6
    s_nop 1
    v_permlane32_swap_b32 v6, v7
    s_nop 1
    v_max_f32 v6, v6, v7
    v_sub_f32 v7, v5, v6
    v_exp_f32 v7, v7
    v_mov_b32 v5, v6
    v_sub_f32 v48, v48, v6
    v_sub_f32 v49, v49, v6
    v_sub_f32 v50, v50, v6
    v_sub_f32 v51, v51, v6
    v_sub_f32 v52, v52, v6
    v_sub_f32 v53, v53, v6
    v_sub_f32 v54, v54, v6
    v_sub_f32 v55, v55, v6
    v_sub_f32 v56, v56, v6
    v_sub_f32 v57, v57, v6
    v_sub_f32 v58, v58, v6
    v_sub_f32 v59, v59, v6
    v_sub_f32 v60, v60, v6
    v_sub_f32 v61, v61, v6
    v_sub_f32 v62, v62, v6
    v_sub_f32 v63, v63, v6
    v_exp_f32 v48, v48
    v_exp_f32 v49, v49
    v_exp_f32 v50, v50
    v_exp_f32 v51, v51
    v_exp_f32 v52, v52
    v_exp_f32 v53, v53
    v_exp_f32 v54, v54
    v_exp_f32 v55, v55
    v_exp_f32 v56, v56
    v_exp_f32 v57, v57
    v_exp_f32 v58, v58
    v_exp_f32 v59, v59
    v_exp_f32 v60, v60
    v_exp_f32 v61, v61
    v_exp_f32 v62, v62
    v_exp_f32 v63, v63
    v_mul_f32 v96, v96, v7
    v_mul_f32 v97, v97, v7
    v_mul_f32 v98, v98, v7
    v_mul_f32 v99, v99, v7
    v_mul_f32 v100, v100, v7
    v_mul_f32 v101, v101, v7
    v_mul_f32 v102, v102, v7
    v_mul_f32 v103, v103, v7
    v_mul_f32 v104, v104, v7
    v_mul_f32 v105, v105, v7
    v_mul_f32 v106, v106, v7
    v_mul_f32 v107, v107, v7
    v_mul_f32 v108, v108, v7
    v_mul_f32 v109, v109, v7
    v_mul_f32 v110, v110, v7
    v_mul_f32 v111, v111, v7
    v_cvt_pk_bf16_f32 v40, v48, v49
    v_cvt_pk_bf16_f32 v41, v50, v51
    v_cvt_pk_bf16_f32 v42, v52, v53
    v_cvt_pk_bf16_f32 v43, v54, v55
    v_cvt_pk_bf16_f32 v44, v56, v57
    v_cvt_pk_bf16_f32 v45, v58, v59
    v_cvt_pk_bf16_f32 v46, v60, v61
    v_cvt_pk_bf16_f32 v47, v62, v63
    s_nop 1
    v_mfma_f32_32x32x16_bf16 v[96:111], v[24:27], v[40:43], v[96:111]
    v_mfma_f32_32x32x16_bf16 v[96:111], v[28:31], v[44:47], v[96:111]
    v_add_u32 v3, 1024, v3
    v_add_u32 v4, 1024, v4
    s_nop 7
    s_nop 7
    s_sub_u32 s18, s18, 1
    s_cmp_lg_u32 s18, 0
    s_cbranch_scc1 k2_kernel_sloop
    s_branch k2_kernel_fin
k2_kernel_gemm:
    s_mov_b32 s25, s3
    s_sub_u32 s3, s3, 8
    s_and_b32 s12, s2, 7
    s_lshl_b32 s12, s12, 2
    s_bfe_u32 s13, s2, 0x20003
    s_add_u32 s12, s12, s13
    s_lshl_b32 s12, s12, 1
    s_lshr_b32 s13, s3, 1
    s_add_u32 s12, s12, s13
    s_lshr_b32 s13, s2, 5
    s_lshl_b32 s13, s13, 1
    s_and_b32 s14, s3, 1
    s_add_u32 s13, s13, s14
    s_mul_i32 s20, s13, 147456
    s_add_u32 s20, s20, 10485760
    s_mul_i32 s21, s12, 114688
    s_add_u32 s21, s21, 16777216
    s_lshl_b32 s19, s12, 4
    s_add_u32 s19, s19, s13
    s_lshl_b32 s19, s19, 11
    s_add_u32 s19, s19, 8388608
    s_add_u32 s22, s20, 4096
    s_add_u32 s23, s21, 4096
    s_barrier
    buffer_load_dwordx4 v[12:15], v2, s[8:11], s20 offen offset:0
    buffer_load_dwordx4 v[44:47], v2, s[8:11], s21 offen offset:0
    buffer_load_dwordx4 v[16:19], v2, s[8:11], s20 offen offset:1024
    buffer_load_dwordx4 v[48:51], v2, s[8:11], s21 offen offset:1024
    buffer_load_dwordx4 v[20:23], v2, s[8:11], s20 offen offset:2048
    buffer_load_dwordx4 v[52:55], v2, s[8:11], s21 offen offset:2048
    buffer_load_dwordx4 v[24:27], v2, s[8:11], s20 offen offset:3072
    buffer_load_dwordx4 v[56:59], v2, s[8:11], s21 offen offset:3072
    buffer_load_dwordx4 v[28:31], v2, s[8:11], s22 offen offset:0
    buffer_load_dwordx4 v[60:63], v2, s[8:11], s23 offen offset:0
    buffer_load_dwordx4 v[32:35], v2, s[8:11], s22 offen offset:1024
    buffer_load_dwordx4 v[64:67], v2, s[8:11], s23 offen offset:1024
    buffer_load_dwordx4 v[36:39], v2, s[8:11], s22 offen offset:2048
    buffer_load_dwordx4 v[68:71], v2, s[8:11], s23 offen offset:2048
    buffer_load_dwordx4 v[40:43], v2, s[8:11], s22 offen offset:3072
    buffer_load_dwordx4 v[72:75], v2, s[8:11], s23 offen offset:3072
    s_add_u32 s20, s20, 8192
    s_add_u32 s21, s21, 8192
    s_add_u32 s22, s22, 8192
    s_add_u32 s23, s23, 8192
    s_waitcnt vmcnt(14)
    v_mfma_f32_32x32x16_bf16 v[80:95], v[12:15], v[44:47], 0
    buffer_load_dwordx4 v[12:15], v2, s[8:11], s20 offen offset:0
    buffer_load_dwordx4 v[44:47], v2, s[8:11], s21 offen offset:0
    s_waitcnt vmcnt(14)
    v_mfma_f32_32x32x16_bf16 v[80:95], v[16:19], v[48:51], v[80:95]
    buffer_load_dwordx4 v[16:19], v2, s[8:11], s20 offen offset:1024
    buffer_load_dwordx4 v[48:51], v2, s[8:11], s21 offen offset:1024
    s_waitcnt vmcnt(14)
    v_mfma_f32_32x32x16_bf16 v[80:95], v[20:23], v[52:55], v[80:95]
    buffer_load_dwordx4 v[20:23], v2, s[8:11], s20 offen offset:2048
    buffer_load_dwordx4 v[52:55], v2, s[8:11], s21 offen offset:2048
    s_waitcnt vmcnt(14)
    v_mfma_f32_32x32x16_bf16 v[80:95], v[24:27], v[56:59], v[80:95]
    buffer_load_dwordx4 v[24:27], v2, s[8:11], s20 offen offset:3072
    buffer_load_dwordx4 v[56:59], v2, s[8:11], s21 offen offset:3072
    s_waitcnt vmcnt(14)
    v_mfma_f32_32x32x16_bf16 v[80:95], v[28:31], v[60:63], v[80:95]
    buffer_load_dwordx4 v[28:31], v2, s[8:11], s22 offen offset:0
    buffer_load_dwordx4 v[60:63], v2, s[8:11], s23 offen offset:0
    s_waitcnt vmcnt(14)
    v_mfma_f32_32x32x16_bf16 v[80:95], v[32:35], v[64:67], v[80:95]
    buffer_load_dwordx4 v[32:35], v2, s[8:11], s22 offen offset:1024
    buffer_load_dwordx4 v[64:67], v2, s[8:11], s23 offen offset:1024
    s_waitcnt vmcnt(14)
    v_mfma_f32_32x32x16_bf16 v[80:95], v[36:39], v[68:71], v[80:95]
    buffer_load_dwordx4 v[36:39], v2, s[8:11], s22 offen offset:2048
    buffer_load_dwordx4 v[68:71], v2, s[8:11], s23 offen offset:2048
    s_waitcnt vmcnt(14)
    v_mfma_f32_32x32x16_bf16 v[80:95], v[40:43], v[72:75], v[80:95]
    buffer_load_dwordx4 v[40:43], v2, s[8:11], s22 offen offset:3072
    buffer_load_dwordx4 v[72:75], v2, s[8:11], s23 offen offset:3072
    s_add_u32 s20, s20, 8192
    s_add_u32 s21, s21, 8192
    s_add_u32 s22, s22, 8192
    s_add_u32 s23, s23, 8192
    s_barrier
    s_waitcnt vmcnt(14)
    v_mfma_f32_32x32x16_bf16 v[80:95], v[12:15], v[44:47], v[80:95]
    buffer_load_dwordx4 v[12:15], v2, s[8:11], s20 offen offset:0
    buffer_load_dwordx4 v[44:47], v2, s[8:11], s21 offen offset:0
    s_waitcnt vmcnt(14)
    v_mfma_f32_32x32x16_bf16 v[80:95], v[16:19], v[48:51], v[80:95]
    buffer_load_dwordx4 v[16:19], v2, s[8:11], s20 offen offset:1024
    buffer_load_dwordx4 v[48:51], v2, s[8:11], s21 offen offset:1024
    s_waitcnt vmcnt(14)
    v_mfma_f32_32x32x16_bf16 v[80:95], v[20:23], v[52:55], v[80:95]
    buffer_load_dwordx4 v[20:23], v2, s[8:11], s20 offen offset:2048
    buffer_load_dwordx4 v[52:55], v2, s[8:11], s21 offen offset:2048
    s_waitcnt vmcnt(14)
    v_mfma_f32_32x32x16_bf16 v[80:95], v[24:27], v[56:59], v[80:95]
    buffer_load_dwordx4 v[24:27], v2, s[8:11], s20 offen offset:3072
    buffer_load_dwordx4 v[56:59], v2, s[8:11], s21 offen offset:3072
    s_waitcnt vmcnt(14)
    v_mfma_f32_32x32x16_bf16 v[80:95], v[28:31], v[60:63], v[80:95]
    buffer_load_dwordx4 v[28:31], v2, s[8:11], s22 offen offset:0
    buffer_load_dwordx4 v[60:63], v2, s[8:11], s23 offen offset:0
    s_waitcnt vmcnt(14)
    v_mfma_f32_32x32x16_bf16 v[80:95], v[32:35], v[64:67], v[80:95]
    buffer_load_dwordx4 v[32:35], v2, s[8:11], s22 offen offset:1024
    buffer_load_dwordx4 v[64:67], v2, s[8:11], s23 offen offset:1024
    s_waitcnt vmcnt(14)
    v_mfma_f32_32x32x16_bf16 v[80:95], v[36:39], v[68:71], v[80:95]
    buffer_load_dwordx4 v[36:39], v2, s[8:11], s22 offen offset:2048
    buffer_load_dwordx4 v[68:71], v2, s[8:11], s23 offen offset:2048
    s_waitcnt vmcnt(14)
    v_mfma_f32_32x32x16_bf16 v[80:95], v[40:43], v[72:75], v[80:95]
    buffer_load_dwordx4 v[40:43], v2, s[8:11], s22 offen offset:3072
    buffer_load_dwordx4 v[72:75], v2, s[8:11], s23 offen offset:3072
    s_add_u32 s20, s20, 8192
    s_add_u32 s21, s21, 8192
    s_add_u32 s22, s22, 8192
    s_add_u32 s23, s23, 8192
    s_waitcnt vmcnt(14)
    v_mfma_f32_32x32x16_bf16 v[80:95], v[12:15], v[44:47], v[80:95]
    buffer_load_dwordx4 v[12:15], v2, s[8:11], s20 offen offset:0
    buffer_load_dwordx4 v[44:47], v2, s[8:11], s21 offen offset:0
    s_waitcnt vmcnt(14)
    v_mfma_f32_32x32x16_bf16 v[80:95], v[16:19], v[48:51], v[80:95]
    buffer_load_dwordx4 v[16:19], v2, s[8:11], s20 offen offset:1024
    buffer_load_dwordx4 v[48:51], v2, s[8:11], s21 offen offset:1024
    s_waitcnt vmcnt(14)
    v_mfma_f32_32x32x16_bf16 v[80:95], v[20:23], v[52:55], v[80:95]
    buffer_load_dwordx4 v[20:23], v2, s[8:11], s20 offen offset:2048
    buffer_load_dwordx4 v[52:55], v2, s[8:11], s21 offen offset:2048
    s_waitcnt vmcnt(14)
    v_mfma_f32_32x32x16_bf16 v[80:95], v[24:27], v[56:59], v[80:95]
    buffer_load_dwordx4 v[24:27], v2, s[8:11], s20 offen offset:3072
    buffer_load_dwordx4 v[56:59], v2, s[8:11], s21 offen offset:3072
    s_waitcnt vmcnt(14)
    v_mfma_f32_32x32x16_bf16 v[80:95], v[28:31], v[60:63], v[80:95]
    buffer_load_dwordx4 v[28:31], v2, s[8:11], s22 offen offset:0
    buffer_load_dwordx4 v[60:63], v2, s[8:11], s23 offen offset:0
    s_waitcnt vmcnt(14)
    v_mfma_f32_32x32x16_bf16 v[80:95], v[32:35], v[64:67], v[80:95]
    buffer_load_dwordx4 v[32:35], v2, s[8:11], s22 offen offset:1024
    buffer_load_dwordx4 v[64:67], v2, s[8:11], s23 offen offset:1024
    s_waitcnt vmcnt(14)
    v_mfma_f32_32x32x16_bf16 v[80:95], v[36:39], v[68:71], v[80:95]
    buffer_load_dwordx4 v[36:39], v2, s[8:11], s22 offen offset:2048
    buffer_load_dwordx4 v[68:71], v2, s[8:11], s23 offen offset:2048
    s_waitcnt vmcnt(14)
    v_mfma_f32_32x32x16_bf16 v[80:95], v[40:43], v[72:75], v[80:95]
    buffer_load_dwordx4 v[40:43], v2, s[8:11], s22 offen offset:3072
    buffer_load_dwordx4 v[72:75], v2, s[8:11], s23 offen offset:3072
    s_add_u32 s20, s20, 8192
    s_add_u32 s21, s21, 8192
    s_add_u32 s22, s22, 8192
    s_add_u32 s23, s23, 8192
    s_waitcnt vmcnt(14)
    v_mfma_f32_32x32x16_bf16 v[80:95], v[12:15], v[44:47], v[80:95]
    buffer_load_dwordx4 v[12:15], v2, s[8:11], s20 offen offset:0
    buffer_load_dwordx4 v[44:47], v2, s[8:11], s21 offen offset:0
    s_waitcnt vmcnt(14)
    v_mfma_f32_32x32x16_bf16 v[80:95], v[16:19], v[48:51], v[80:95]
    buffer_load_dwordx4 v[16:19], v2, s[8:11], s20 offen offset:1024
    buffer_load_dwordx4 v[48:51], v2, s[8:11], s21 offen offset:1024
    s_waitcnt vmcnt(14)
    v_mfma_f32_32x32x16_bf16 v[80:95], v[20:23], v[52:55], v[80:95]
    buffer_load_dwordx4 v[20:23], v2, s[8:11], s20 offen offset:2048
    buffer_load_dwordx4 v[52:55], v2, s[8:11], s21 offen offset:2048
    s_waitcnt vmcnt(14)
    v_mfma_f32_32x32x16_bf16 v[80:95], v[24:27], v[56:59], v[80:95]
    buffer_load_dwordx4 v[24:27], v2, s[8:11], s20 offen offset:3072
    buffer_load_dwordx4 v[56:59], v2, s[8:11], s21 offen offset:3072
    s_waitcnt vmcnt(14)
    v_mfma_f32_32x32x16_bf16 v[80:95], v[28:31], v[60:63], v[80:95]
    buffer_load_dwordx4 v[28:31], v2, s[8:11], s22 offen offset:0
    buffer_load_dwordx4 v[60:63], v2, s[8:11], s23 offen offset:0
    s_waitcnt vmcnt(14)
    v_mfma_f32_32x32x16_bf16 v[80:95], v[32:35], v[64:67], v[80:95]
    buffer_load_dwordx4 v[32:35], v2, s[8:11], s22 offen offset:1024
    buffer_load_dwordx4 v[64:67], v2, s[8:11], s23 offen offset:1024
    s_waitcnt vmcnt(14)
    v_mfma_f32_32x32x16_bf16 v[80:95], v[36:39], v[68:71], v[80:95]
    buffer_load_dwordx4 v[36:39], v2, s[8:11], s22 offen offset:2048
    buffer_load_dwordx4 v[68:71], v2, s[8:11], s23 offen offset:2048
    s_waitcnt vmcnt(14)
    v_mfma_f32_32x32x16_bf16 v[80:95], v[40:43], v[72:75], v[80:95]
    buffer_load_dwordx4 v[40:43], v2, s[8:11], s22 offen offset:3072
    buffer_load_dwordx4 v[72:75], v2, s[8:11], s23 offen offset:3072
    s_add_u32 s20, s20, 8192
    s_add_u32 s21, s21, 8192
    s_add_u32 s22, s22, 8192
    s_add_u32 s23, s23, 8192
    s_barrier
    s_mov_b32 s18, 9
k2_kernel_gloop:
    s_waitcnt vmcnt(14)
    v_mfma_f32_32x32x16_bf16 v[80:95], v[12:15], v[44:47], v[80:95]
    buffer_load_dwordx4 v[12:15], v2, s[8:11], s20 offen offset:0
    buffer_load_dwordx4 v[44:47], v2, s[8:11], s21 offen offset:0
    s_waitcnt vmcnt(14)
    v_mfma_f32_32x32x16_bf16 v[80:95], v[16:19], v[48:51], v[80:95]
    buffer_load_dwordx4 v[16:19], v2, s[8:11], s20 offen offset:1024
    buffer_load_dwordx4 v[48:51], v2, s[8:11], s21 offen offset:1024
    s_waitcnt vmcnt(14)
    v_mfma_f32_32x32x16_bf16 v[80:95], v[20:23], v[52:55], v[80:95]
    buffer_load_dwordx4 v[20:23], v2, s[8:11], s20 offen offset:2048
    buffer_load_dwordx4 v[52:55], v2, s[8:11], s21 offen offset:2048
    s_waitcnt vmcnt(14)
    v_mfma_f32_32x32x16_bf16 v[80:95], v[24:27], v[56:59], v[80:95]
    buffer_load_dwordx4 v[24:27], v2, s[8:11], s20 offen offset:3072
    buffer_load_dwordx4 v[56:59], v2, s[8:11], s21 offen offset:3072
    s_waitcnt vmcnt(14)
    v_mfma_f32_32x32x16_bf16 v[80:95], v[28:31], v[60:63], v[80:95]
    buffer_load_dwordx4 v[28:31], v2, s[8:11], s22 offen offset:0
    buffer_load_dwordx4 v[60:63], v2, s[8:11], s23 offen offset:0
    s_waitcnt vmcnt(14)
    v_mfma_f32_32x32x16_bf16 v[80:95], v[32:35], v[64:67], v[80:95]
    buffer_load_dwordx4 v[32:35], v2, s[8:11], s22 offen offset:1024
    buffer_load_dwordx4 v[64:67], v2, s[8:11], s23 offen offset:1024
    s_waitcnt vmcnt(14)
    v_mfma_f32_32x32x16_bf16 v[80:95], v[36:39], v[68:71], v[80:95]
    buffer_load_dwordx4 v[36:39], v2, s[8:11], s22 offen offset:2048
    buffer_load_dwordx4 v[68:71], v2, s[8:11], s23 offen offset:2048
    s_waitcnt vmcnt(14)
    v_mfma_f32_32x32x16_bf16 v[80:95], v[40:43], v[72:75], v[80:95]
    buffer_load_dwordx4 v[40:43], v2, s[8:11], s22 offen offset:3072
    buffer_load_dwordx4 v[72:75], v2, s[8:11], s23 offen offset:3072
    s_add_u32 s20, s20, 8192
    s_add_u32 s21, s21, 8192
    s_add_u32 s22, s22, 8192
    s_add_u32 s23, s23, 8192
    s_sub_u32 s18, s18, 1
    s_cmp_lg_u32 s18, 0
    s_cbranch_scc1 k2_kernel_gloop
    s_waitcnt vmcnt(14)
    v_mfma_f32_32x32x16_bf16 v[80:95], v[12:15], v[44:47], v[80:95]
    s_waitcnt vmcnt(12)
    v_mfma_f32_32x32x16_bf16 v[80:95], v[16:19], v[48:51], v[80:95]
    s_waitcnt vmcnt(10)
    v_mfma_f32_32x32x16_bf16 v[80:95], v[20:23], v[52:55], v[80:95]
    s_waitcnt vmcnt(8)
    v_mfma_f32_32x32x16_bf16 v[80:95], v[24:27], v[56:59], v[80:95]
    s_waitcnt vmcnt(6)
    v_mfma_f32_32x32x16_bf16 v[80:95], v[28:31], v[60:63], v[80:95]
    s_waitcnt vmcnt(4)
    v_mfma_f32_32x32x16_bf16 v[80:95], v[32:35], v[64:67], v[80:95]
    s_waitcnt vmcnt(2)
    v_mfma_f32_32x32x16_bf16 v[80:95], v[36:39], v[68:71], v[80:95]
    s_waitcnt vmcnt(0)
    v_mfma_f32_32x32x16_bf16 v[80:95], v[40:43], v[72:75], v[80:95]
    s_mov_b32 s12, 0xbfb8aa3b
    s_nop 7
    s_nop 3
    v_mul_f32 v96, s12, v80
    v_mul_f32 v97, s12, v81
    v_mul_f32 v98, s12, v82
    v_mul_f32 v99, s12, v83
    v_mul_f32 v100, s12, v84
    v_mul_f32 v101, s12, v85
    v_mul_f32 v102, s12, v86
    v_mul_f32 v103, s12, v87
    v_mul_f32 v104, s12, v88
    v_mul_f32 v105, s12, v89
    v_mul_f32 v106, s12, v90
    v_mul_f32 v107, s12, v91
    v_mul_f32 v108, s12, v92
    v_mul_f32 v109, s12, v93
    v_mul_f32 v110, s12, v94
    v_mul_f32 v111, s12, v95
    v_exp_f32 v96, v96
    v_exp_f32 v97, v97
    v_exp_f32 v98, v98
    v_exp_f32 v99, v99
    v_exp_f32 v100, v100
    v_exp_f32 v101, v101
    v_exp_f32 v102, v102
    v_exp_f32 v103, v103
    v_exp_f32 v104, v104
    v_exp_f32 v105, v105
    v_exp_f32 v106, v106
    v_exp_f32 v107, v107
    v_exp_f32 v108, v108
    v_exp_f32 v109, v109
    v_exp_f32 v110, v110
    v_exp_f32 v111, v111
    v_add_f32 v96, 1.0, v96
    v_add_f32 v97, 1.0, v97
    v_add_f32 v98, 1.0, v98
    v_add_f32 v99, 1.0, v99
    v_add_f32 v100, 1.0, v100
    v_add_f32 v101, 1.0, v101
    v_add_f32 v102, 1.0, v102
    v_add_f32 v103, 1.0, v103
    v_add_f32 v104, 1.0, v104
    v_add_f32 v105, 1.0, v105
    v_add_f32 v106, 1.0, v106
    v_add_f32 v107, 1.0, v107
    v_add_f32 v108, 1.0, v108
    v_add_f32 v109, 1.0, v109
    v_add_f32 v110, 1.0, v110
    v_add_f32 v111, 1.0, v111
    v_rcp_f32 v96, v96
    v_rcp_f32 v97, v97
    v_rcp_f32 v98, v98
    v_rcp_f32 v99, v99
    v_rcp_f32 v100, v100
    v_rcp_f32 v101, v101
    v_rcp_f32 v102, v102
    v_rcp_f32 v103, v103
    v_rcp_f32 v104, v104
    v_rcp_f32 v105, v105
    v_rcp_f32 v106, v106
    v_rcp_f32 v107, v107
    v_rcp_f32 v108, v108
    v_rcp_f32 v109, v109
    v_rcp_f32 v110, v110
    v_rcp_f32 v111, v111
    v_mul_f32 v96, v96, v80
    v_mul_f32 v97, v97, v81
    v_mul_f32 v98, v98, v82
    v_mul_f32 v99, v99, v83
    v_mul_f32 v100, v100, v84
    v_mul_f32 v101, v101, v85
    v_mul_f32 v102, v102, v86
    v_mul_f32 v103, v103, v87
    v_mul_f32 v104, v104, v88
    v_mul_f32 v105, v105, v89
    v_mul_f32 v106, v106, v90
    v_mul_f32 v107, v107, v91
    v_mul_f32 v108, v108, v92
    v_mul_f32 v109, v109, v93
    v_mul_f32 v110, v110, v94
    v_mul_f32 v111, v111, v95
    v_cvt_pk_bf16_f32 v12, v96, v97
    v_cvt_pk_bf16_f32 v13, v98, v99
    v_cvt_pk_bf16_f32 v14, v100, v101
    v_cvt_pk_bf16_f32 v15, v102, v103
    v_cvt_pk_bf16_f32 v16, v104, v105
    v_cvt_pk_bf16_f32 v17, v106, v107
    v_cvt_pk_bf16_f32 v18, v108, v109
    v_cvt_pk_bf16_f32 v19, v110, v111
    buffer_store_dwordx4 v[12:15], v2, s[8:11], s19 offen sc1
    buffer_store_dwordx4 v[16:19], v2, s[8:11], s19 offen offset:1024 sc1
k2_kernel_end:
    s_endpgm
.p2align 8
.globl k3_kernel
.type k3_kernel,@function
k3_kernel:
    s_cmp_ge_u32 s2, 256
    s_cbranch_scc1 k3_kernel_end
    s_load_dwordx2 s[6:7], s[0:1], 72
    s_load_dwordx2 s[28:29], s[0:1], 0
    s_load_dwordx2 s[30:31], s[0:1], 56
    v_lshrrev_b32 v2, 6, v0
    v_and_b32 v1, 63, v0
    s_nop 0
    v_readfirstlane_b32 s3, v2
    v_lshlrev_b32 v2, 4, v1
    s_and_b32 s32, s2, 7
    s_lshl_b32 s32, s32, 2
    s_bfe_u32 s33, s2, 0x20003
    s_add_u32 s32, s32, s33
    s_lshl_b32 s32, s32, 1
    s_lshr_b32 s33, s2, 5
    s_lshl_b32 s33, s33, 1
    s_mul_i32 s23, s33, 147456
    s_lshl_b32 s20, s3, 13
    s_add_u32 s23, s23, s20
    s_add_u32 s23, s23, 10600448
    s_lshl_b32 s24, s32, 15
    s_add_u32 s24, s24, s20
    s_add_u32 s24, s24, 6291456
    s_lshr_b32 s20, s3, 1
    s_add_u32 s20, s20, s32
    s_and_b32 s21, s3, 1
    s_add_u32 s21, s21, s33
    s_lshl_b32 s25, s20, 4
    s_add_u32 s25, s25, s21
    s_lshl_b32 s25, s25, 11
    s_add_u32 s25, s25, 8388608
    s_lshl_b32 s26, s20, 15
    s_lshl_b32 s22, s21, 6
    s_add_u32 s26, s26, s22
    v_and_b32 v3, 31, v1
    v_lshlrev_b32 v3, 10, v3
    v_lshrrev_b32 v4, 5, v1
    v_lshl_add_u32 v3, v4, 3, v3
    s_waitcnt lgkmcnt(0)
    s_mov_b32 s8, s6
    s_and_b32 s9, s7, 0xffff
    s_mov_b32 s10, 33554432
    s_mov_b32 s11, 0x00020000
    s_mov_b32 s12, s28
    s_and_b32 s13, s29, 0xffff
    s_mov_b32 s14, 2097152
    s_mov_b32 s15, 0x00020000
    s_mov_b32 s16, s30
    s_and_b32 s17, s31, 0xffff
    s_mov_b32 s18, 2097152
    s_mov_b32 s19, 0x00020000
    s_add_u32 s34, s23, 4096
    s_add_u32 s35, s23, 147456
    s_add_u32 s36, s23, 151552
    s_add_u32 s37, s24, 4096
    s_add_u32 s38, s24, 32768
    s_add_u32 s39, s24, 36864
    buffer_load_dwordx4 v[104:107], v2, s[8:11], s23 offen offset:0
    buffer_load_dwordx4 v[168:171], v2, s[8:11], s24 offen offset:0
    buffer_load_dwordx4 v[136:139], v2, s[8:11], s35 offen offset:0
    buffer_load_dwordx4 v[200:203], v2, s[8:11], s38 offen offset:0
    buffer_load_dwordx4 v[108:111], v2, s[8:11], s23 offen offset:1024
    buffer_load_dwordx4 v[172:175], v2, s[8:11], s24 offen offset:1024
    buffer_load_dwordx4 v[140:143], v2, s[8:11], s35 offen offset:1024
    buffer_load_dwordx4 v[204:207], v2, s[8:11], s38 offen offset:1024
    buffer_load_dwordx4 v[112:115], v2, s[8:11], s23 offen offset:2048
    buffer_load_dwordx4 v[176:179], v2, s[8:11], s24 offen offset:2048
    buffer_load_dwordx4 v[144:147], v2, s[8:11], s35 offen offset:2048
    buffer_load_dwordx4 v[208:211], v2, s[8:11], s38 offen offset:2048
    buffer_load_dwordx4 v[116:119], v2, s[8:11], s23 offen offset:3072
    buffer_load_dwordx4 v[180:183], v2, s[8:11], s24 offen offset:3072
    buffer_load_dwordx4 v[148:151], v2, s[8:11], s35 offen offset:3072
    buffer_load_dwordx4 v[212:215], v2, s[8:11], s38 offen offset:3072
    buffer_load_dwordx4 v[120:123], v2, s[8:11], s34 offen offset:0
    buffer_load_dwordx4 v[184:187], v2, s[8:11], s37 offen offset:0
    buffer_load_dwordx4 v[152:155], v2, s[8:11], s36 offen offset:0
    buffer_load_dwordx4 v[216:219], v2, s[8:11], s39 offen offset:0
    buffer_load_dwordx4 v[124:127], v2, s[8:11], s34 offen offset:1024
    buffer_load_dwordx4 v[188:191], v2, s[8:11], s37 offen offset:1024
    buffer_load_dwordx4 v[156:159], v2, s[8:11], s36 offen offset:1024
    buffer_load_dwordx4 v[220:223], v2, s[8:11], s39 offen offset:1024
    buffer_load_dwordx4 v[128:131], v2, s[8:11], s34 offen offset:2048
    buffer_load_dwordx4 v[192:195], v2, s[8:11], s37 offen offset:2048
    buffer_load_dwordx4 v[160:163], v2, s[8:11], s36 offen offset:2048
    buffer_load_dwordx4 v[224:227], v2, s[8:11], s39 offen offset:2048
    buffer_load_dwordx4 v[132:135], v2, s[8:11], s34 offen offset:3072
    buffer_load_dwordx4 v[196:199], v2, s[8:11], s37 offen offset:3072
    buffer_load_dwordx4 v[164:167], v2, s[8:11], s36 offen offset:3072
    buffer_load_dwordx4 v[228:231], v2, s[8:11], s39 offen offset:3072
    buffer_load_dwordx4 v[4:7], v2, s[8:11], s25 offen
    buffer_load_dwordx4 v[8:11], v2, s[8:11], s25 offen offset:1024
    buffer_load_dwordx2 v[12:13], v3, s[12:15], s26 offen offset:0
    buffer_load_dwordx2 v[14:15], v3, s[12:15], s26 offen offset:16
    buffer_load_dwordx2 v[16:17], v3, s[12:15], s26 offen offset:32
    buffer_load_dwordx2 v[18:19], v3, s[12:15], s26 offen offset:48
    s_lshl_b32 s20, s3, 12
    v_add_u32 v36, s20, v2
    s_waitcnt vmcnt(34)
    v_mfma_f32_32x32x16_bf16 v[40:55], v[104:107], v[168:171], 0
    v_mfma_f32_32x32x16_bf16 v[56:71], v[136:139], v[168:171], 0
    v_mfma_f32_32x32x16_bf16 v[72:87], v[104:107], v[200:203], 0
    v_mfma_f32_32x32x16_bf16 v[88:103], v[136:139], v[200:203], 0
    s_waitcnt vmcnt(30)
    v_mfma_f32_32x32x16_bf16 v[40:55], v[108:111], v[172:175], v[40:55]
    v_mfma_f32_32x32x16_bf16 v[56:71], v[140:143], v[172:175], v[56:71]
    v_mfma_f32_32x32x16_bf16 v[72:87], v[108:111], v[204:207], v[72:87]
    v_mfma_f32_32x32x16_bf16 v[88:103], v[140:143], v[204:207], v[88:103]
    s_waitcnt vmcnt(26)
    v_mfma_f32_32x32x16_bf16 v[40:55], v[112:115], v[176:179], v[40:55]
    v_mfma_f32_32x32x16_bf16 v[56:71], v[144:147], v[176:179], v[56:71]
    v_mfma_f32_32x32x16_bf16 v[72:87], v[112:115], v[208:211], v[72:87]
    v_mfma_f32_32x32x16_bf16 v[88:103], v[144:147], v[208:211], v[88:103]
    s_waitcnt vmcnt(22)
    v_mfma_f32_32x32x16_bf16 v[40:55], v[116:119], v[180:183], v[40:55]
    v_mfma_f32_32x32x16_bf16 v[56:71], v[148:151], v[180:183], v[56:71]
    v_mfma_f32_32x32x16_bf16 v[72:87], v[116:119], v[212:215], v[72:87]
    v_mfma_f32_32x32x16_bf16 v[88:103], v[148:151], v[212:215], v[88:103]
    s_waitcnt vmcnt(18)
    v_mfma_f32_32x32x16_bf16 v[40:55], v[120:123], v[184:187], v[40:55]
    v_mfma_f32_32x32x16_bf16 v[56:71], v[152:155], v[184:187], v[56:71]
    v_mfma_f32_32x32x16_bf16 v[72:87], v[120:123], v[216:219], v[72:87]
    v_mfma_f32_32x32x16_bf16 v[88:103], v[152:155], v[216:219], v[88:103]
    s_waitcnt vmcnt(14)
    v_mfma_f32_32x32x16_bf16 v[40:55], v[124:127], v[188:191], v[40:55]
    v_mfma_f32_32x32x16_bf16 v[56:71], v[156:159], v[188:191], v[56:71]
    v_mfma_f32_32x32x16_bf16 v[72:87], v[124:127], v[220:223], v[72:87]
    v_mfma_f32_32x32x16_bf16 v[88:103], v[156:159], v[220:223], v[88:103]
    s_waitcnt vmcnt(10)
    v_mfma_f32_32x32x16_bf16 v[40:55], v[128:131], v[192:195], v[40:55]
    v_mfma_f32_32x32x16_bf16 v[56:71], v[160:163], v[192:195], v[56:71]
    v_mfma_f32_32x32x16_bf16 v[72:87], v[128:131], v[224:227], v[72:87]
    v_mfma_f32_32x32x16_bf16 v[88:103], v[160:163], v[224:227], v[88:103]
    s_waitcnt vmcnt(6)
    v_mfma_f32_32x32x16_bf16 v[40:55], v[132:135], v[196:199], v[40:55]
    v_mfma_f32_32x32x16_bf16 v[56:71], v[164:167], v[196:199], v[56:71]
    v_mfma_f32_32x32x16_bf16 v[72:87], v[132:135], v[228:231], v[72:87]
    v_mfma_f32_32x32x16_bf16 v[88:103], v[164:167], v[228:231], v[88:103]
    s_nop 7
    s_nop 3
    ds_write_b128 v36, v[40:43] offset:0
    ds_write_b128 v36, v[44:47] offset:1024
    ds_write_b128 v36, v[48:51] offset:2048
    ds_write_b128 v36, v[52:55] offset:3072
    ds_write_b128 v36, v[56:59] offset:16384
    ds_write_b128 v36, v[60:63] offset:17408
    ds_write_b128 v36, v[64:67] offset:18432
    ds_write_b128 v36, v[68:71] offset:19456
    ds_write_b128 v36, v[72:75] offset:32768
    ds_write_b128 v36, v[76:79] offset:33792
    ds_write_b128 v36, v[80:83] offset:34816
    ds_write_b128 v36, v[84:87] offset:35840
    ds_write_b128 v36, v[88:91] offset:49152
    ds_write_b128 v36, v[92:95] offset:50176
    ds_write_b128 v36, v[96:99] offset:51200
    ds_write_b128 v36, v[100:103] offset:52224
    s_waitcnt lgkmcnt(0)
    s_barrier
    s_lshl_b32 s20, s3, 14
    v_add_u32 v36, s20, v2
    ds_read_b128 v[104:107], v36 offset:0
    ds_read_b128 v[108:111], v36 offset:1024
    ds_read_b128 v[112:115], v36 offset:2048
    ds_read_b128 v[116:119], v36 offset:3072
    ds_read_b128 v[120:123], v36 offset:4096
    ds_read_b128 v[124:127], v36 offset:5120
    ds_read_b128 v[128:131], v36 offset:6144
    ds_read_b128 v[132:135], v36 offset:7168
    ds_read_b128 v[136:139], v36 offset:8192
    ds_read_b128 v[140:143], v36 offset:9216
    ds_read_b128 v[144:147], v36 offset:10240
    ds_read_b128 v[148:151], v36 offset:11264
    ds_read_b128 v[152:155], v36 offset:12288
    ds_read_b128 v[156:159], v36 offset:13312
    ds_read_b128 v[160:163], v36 offset:14336
    ds_read_b128 v[164:167], v36 offset:15360
    s_mov_b32 s27, 0xffff0000
    s_waitcnt vmcnt(0) lgkmcnt(0)
    v_add_f32 v40, v104, v120
    v_add_f32 v41, v105, v121
    v_add_f32 v42, v106, v122
    v_add_f32 v43, v107, v123
    v_add_f32 v44, v108, v124
    v_add_f32 v45, v109, v125
    v_add_f32 v46, v110, v126
    v_add_f32 v47, v111, v127
    v_add_f32 v48, v112, v128
    v_add_f32 v49, v113, v129
    v_add_f32 v50, v114, v130
    v_add_f32 v51, v115, v131
    v_add_f32 v52, v116, v132
    v_add_f32 v53, v117, v133
    v_add_f32 v54, v118, v134
    v_add_f32 v55, v119, v135
    v_add_f32 v136, v136, v152
    v_add_f32 v137, v137, v153
    v_add_f32 v138, v138, v154
    v_add_f32 v139, v139, v155
    v_add_f32 v140, v140, v156
    v_add_f32 v141, v141, v157
    v_add_f32 v142, v142, v158
    v_add_f32 v143, v143, v159
    v_add_f32 v144, v144, v160
    v_add_f32 v145, v145, v161
    v_add_f32 v146, v146, v162
    v_add_f32 v147, v147, v163
    v_add_f32 v148, v148, v164
    v_add_f32 v149, v149, v165
    v_add_f32 v150, v150, v166
    v_add_f32 v151, v151, v167
    v_add_f32 v40, v40, v136
    v_add_f32 v41, v41, v137
    v_add_f32 v42, v42, v138
    v_add_f32 v43, v43, v139
    v_add_f32 v44, v44, v140
    v_add_f32 v45, v45, v141
    v_add_f32 v46, v46, v142
    v_add_f32 v47, v47, v143
    v_add_f32 v48, v48, v144
    v_add_f32 v49, v49, v145
    v_add_f32 v50, v50, v146
    v_add_f32 v51, v51, v147
    v_add_f32 v52, v52, v148
    v_add_f32 v53, v53, v149
    v_add_f32 v54, v54, v150
    v_add_f32 v55, v55, v151
    v_cvt_pk_bf16_f32 v168, v40, v41
    v_cvt_pk_bf16_f32 v169, v42, v43
    v_cvt_pk_bf16_f32 v170, v44, v45
    v_cvt_pk_bf16_f32 v171, v46, v47
    v_cvt_pk_bf16_f32 v172, v48, v49
    v_cvt_pk_bf16_f32 v173, v50, v51
    v_cvt_pk_bf16_f32 v174, v52, v53
    v_cvt_pk_bf16_f32 v175, v54, v55
    v_lshlrev_b32 v40, 16, v168
    v_and_b32 v41, s27, v168
    v_lshlrev_b32 v176, 16, v4
    v_and_b32 v177, s27, v4
    v_lshlrev_b32 v42, 16, v169
    v_and_b32 v43, s27, v169
    v_lshlrev_b32 v178, 16, v5
    v_and_b32 v179, s27, v5
    v_lshlrev_b32 v44, 16, v170
    v_and_b32 v45, s27, v170
    v_lshlrev_b32 v180, 16, v6
    v_and_b32 v181, s27, v6
    v_lshlrev_b32 v46, 16, v171
    v_and_b32 v47, s27, v171
    v_lshlrev_b32 v182, 16, v7
    v_and_b32 v183, s27, v7
    v_lshlrev_b32 v48, 16, v172
    v_and_b32 v49, s27, v172
    v_lshlrev_b32 v184, 16, v8
    v_and_b32 v185, s27, v8
    v_lshlrev_b32 v50, 16, v173
    v_and_b32 v51, s27, v173
    v_lshlrev_b32 v186, 16, v9
    v_and_b32 v187, s27, v9
    v_lshlrev_b32 v52, 16, v174
    v_and_b32 v53, s27, v174
    v_lshlrev_b32 v188, 16, v10
    v_and_b32 v189, s27, v10
    v_lshlrev_b32 v54, 16, v175
    v_and_b32 v55, s27, v175
    v_lshlrev_b32 v190, 16, v11
    v_and_b32 v191, s27, v11
    v_mul_f32 v40, v40, v176
    v_mul_f32 v41, v41, v177
    v_mul_f32 v42, v42, v178
    v_mul_f32 v43, v43, v179
    v_mul_f32 v44, v44, v180
    v_mul_f32 v45, v45, v181
    v_mul_f32 v46, v46, v182
    v_mul_f32 v47, v47, v183
    v_mul_f32 v48, v48, v184
    v_mul_f32 v49, v49, v185
    v_mul_f32 v50, v50, v186
    v_mul_f32 v51, v51, v187
    v_mul_f32 v52, v52, v188
    v_mul_f32 v53, v53, v189
    v_mul_f32 v54, v54, v190
    v_mul_f32 v55, v55, v191
    v_cvt_pk_bf16_f32 v168, v40, v41
    v_cvt_pk_bf16_f32 v169, v42, v43
    v_cvt_pk_bf16_f32 v170, v44, v45
    v_cvt_pk_bf16_f32 v171, v46, v47
    v_cvt_pk_bf16_f32 v172, v48, v49
    v_cvt_pk_bf16_f32 v173, v50, v51
    v_cvt_pk_bf16_f32 v174, v52, v53
    v_cvt_pk_bf16_f32 v175, v54, v55
    v_lshlrev_b32 v40, 16, v168
    v_and_b32 v41, s27, v168
    v_lshlrev_b32 v176, 16, v12
    v_and_b32 v177, s27, v12
    v_lshlrev_b32 v42, 16, v169
    v_and_b32 v43, s27, v169
    v_lshlrev_b32 v178, 16, v13
    v_and_b32 v179, s27, v13
    v_lshlrev_b32 v44, 16, v170
    v_and_b32 v45, s27, v170
    v_lshlrev_b32 v180, 16, v14
    v_and_b32 v181, s27, v14
    v_lshlrev_b32 v46, 16, v171
    v_and_b32 v47, s27, v171
    v_lshlrev_b32 v182, 16, v15
    v_and_b32 v183, s27, v15
    v_lshlrev_b32 v48, 16, v172
    v_and_b32 v49, s27, v172
    v_lshlrev_b32 v184, 16, v16
    v_and_b32 v185, s27, v16
    v_lshlrev_b32 v50, 16, v173
    v_and_b32 v51, s27, v173
    v_lshlrev_b32 v186, 16, v17
    v_and_b32 v187, s27, v17
    v_lshlrev_b32 v52, 16, v174
    v_and_b32 v53, s27, v174
    v_lshlrev_b32 v188, 16, v18
    v_and_b32 v189, s27, v18
    v_lshlrev_b32 v54, 16, v175
    v_and_b32 v55, s27, v175
    v_lshlrev_b32 v190, 16, v19
    v_and_b32 v191, s27, v19
    v_add_f32 v40, v40, v176
    v_add_f32 v41, v41, v177
    v_add_f32 v42, v42, v178
    v_add_f32 v43, v43, v179
    v_add_f32 v44, v44, v180
    v_add_f32 v45, v45, v181
    v_add_f32 v46, v46, v182
    v_add_f32 v47, v47, v183
    v_add_f32 v48, v48, v184
    v_add_f32 v49, v49, v185
    v_add_f32 v50, v50, v186
    v_add_f32 v51, v51, v187
    v_add_f32 v52, v52, v188
    v_add_f32 v53, v53, v189
    v_add_f32 v54, v54, v190
    v_add_f32 v55, v55, v191
    v_cvt_pk_bf16_f32 v168, v40, v41
    v_cvt_pk_bf16_f32 v169, v42, v43
    v_cvt_pk_bf16_f32 v170, v44, v45
    v_cvt_pk_bf16_f32 v171, v46, v47
    v_cvt_pk_bf16_f32 v172, v48, v49
    v_cvt_pk_bf16_f32 v173, v50, v51
    v_cvt_pk_bf16_f32 v174, v52, v53
    v_cvt_pk_bf16_f32 v175, v54, v55
    buffer_store_dwordx2 v[168:169], v3, s[16:19], s26 offen offset:0
    buffer_store_dwordx2 v[170:171], v3, s[16:19], s26 offen offset:16
    buffer_store_dwordx2 v[172:173], v3, s[16:19], s26 offen offset:32
    buffer_store_dwordx2 v[174:175], v3, s[16:19], s26 offen offset:48
k3_kernel_end:
    s_endpgm
.section .rodata,"a"
.p2align 6

.amdhsa_kernel k1_kernel
  .amdhsa_next_free_vgpr 256
  .amdhsa_next_free_sgpr 102
  .amdhsa_accum_offset 176
  .amdhsa_group_segment_fixed_size 0
  .amdhsa_kernarg_size 80
  .amdhsa_user_sgpr_count 2
  .amdhsa_user_sgpr_kernarg_segment_ptr 1
  .amdhsa_system_sgpr_workgroup_id_x 1
.end_amdhsa_kernel

.amdhsa_kernel k2_kernel
  .amdhsa_next_free_vgpr 112
  .amdhsa_next_free_sgpr 64
  .amdhsa_accum_offset 112
  .amdhsa_group_segment_fixed_size 0
  .amdhsa_kernarg_size 80
  .amdhsa_user_sgpr_count 2
  .amdhsa_user_sgpr_kernarg_segment_ptr 1
  .amdhsa_system_sgpr_workgroup_id_x 1
.end_amdhsa_kernel

.amdhsa_kernel k3_kernel
  .amdhsa_next_free_vgpr 232
  .amdhsa_next_free_sgpr 64
  .amdhsa_accum_offset 232
  .amdhsa_group_segment_fixed_size 0
  .amdhsa_kernarg_size 80
  .amdhsa_user_sgpr_count 2
  .amdhsa_user_sgpr_kernarg_segment_ptr 1
  .amdhsa_system_sgpr_workgroup_id_x 1
.end_amdhsa_kernel
```
